```python
import torch

def _softmax(x, axis=-1):
    return torch.softmax(x, dim=axis)
def _gelu(x):
    return torch.nn.functional.gelu(x, approximate="tanh")
def _silu(x):
    return torch.nn.functional.silu(x)
def _sigmoid(x):
    return torch.sigmoid(x)
def _layernorm(x, axis=-1, eps=1e-5):
    m = x.mean(dim=axis, keepdim=True)
    v = x.var(dim=axis, keepdim=True, unbiased=False)
    return (x - m) / torch.sqrt(v + eps)
def _scatter_add(tgt, idx, src, axis=0):
    return tgt.clone().index_add_(axis, idx, src)
def _segment_sum(src, seg, n):
    out = torch.zeros((n,) + src.shape[1:], dtype=src.dtype)
    return out.index_add_(0, seg, src)
def _pad(x, pw):
    flat = tuple(v for pair in reversed(pw) for v in pair)
    return torch.nn.functional.pad(x, flat)

kernel_name = 'parallel_sum__mha_block_cached__geglu_ffn__decode'

def setup_inputs():

    _w = (lambda a: (lambda t: t.to(torch.bfloat16) if t.is_floating_point() else t)(torch.as_tensor(a)))
    def _A_setup():
        B, Sq, D = 4, 1, 448
        H, Sk, Dh = 16, 4096, 256
        return {
            "x": _w((lambda *s: torch.randn(*s, dtype=torch.bfloat16) * 0.05)(B, Sq, D)),
            "k_cache": _w((lambda *s: torch.randn(*s, dtype=torch.bfloat16) * 3.2)(B, H, Sk, Dh)),
            "v_cache": _w((lambda *s: torch.randn(*s, dtype=torch.bfloat16) * 1.6)(B, H, Sk, Dh)),
            "wq": _w((lambda *s: torch.randn(*s, dtype=torch.bfloat16) * 3.2)(D, H * Dh) * (D ** -0.5)),
            "wo": _w((lambda *s: torch.randn(*s, dtype=torch.bfloat16) * 1.6)(H * Dh, D) * ((H * Dh) ** -0.5)),
        }
    _A_in = _A_setup()

    def _B_setup():
        B, S, D, F = 4, 1, 448, 1792
        return {
            "x": _w((lambda *s: torch.randn(*s, dtype=torch.bfloat16) * 0.05)(B, S, D)),
            "w_gate": _w((lambda *s: torch.randn(*s, dtype=torch.bfloat16) * 0.05)(D, F)),
            "w_up": _w((lambda *s: torch.randn(*s, dtype=torch.bfloat16) * 0.05)(D, F)),
            "w_down": _w((lambda *s: torch.randn(*s, dtype=torch.bfloat16) * 0.05)(F, D)),
        }
    _B_in = _B_setup()

    return {
        "A_x": _A_in["x"],
        "A_k_cache": _A_in["k_cache"],
        "A_v_cache": _A_in["v_cache"],
        "A_wq": _A_in["wq"],
        "A_wo": _A_in["wo"],
        "B_x": _B_in["x"],
        "B_w_gate": _B_in["w_gate"],
        "B_w_up": _B_in["w_up"],
        "B_w_down": _B_in["w_down"],
    }

def reference(A_x, A_k_cache, A_v_cache, A_wq, A_wo, B_x, B_w_gate, B_w_up, B_w_down):
    def _A_ref(x, k_cache, v_cache, wq, wo):
        B, Sq, D = x.shape
        H, Dh = 16, 256
        q = (lambda x, *d: x.permute(*d))((x @ wq).reshape(B, Sq, H, Dh), 0, 2, 1, 3)
        scores = torch.einsum("bhqd,bhkd->bhqk", q, k_cache) * (Dh ** -0.5)
        p = _softmax(scores, axis=-1)
        o = torch.einsum("bhqk,bhkd->bhqd", p, v_cache)
        return (lambda x, *d: x.permute(*d))(o, 0, 2, 1, 3).reshape(B, Sq, H * Dh) @ wo

    def _B_ref(x, w_gate, w_up, w_down):
        return (_gelu(x @ w_gate) * (x @ w_up)) @ w_down

    x = A_x
    xn = _layernorm(x, axis=-1)
    return x + _A_ref(xn, A_k_cache, A_v_cache, A_wq, A_wo) + _B_ref(xn, B_w_gate, B_w_up, B_w_down)
```

```asm
; @launch grid=(256,1,1) block=(512,1,1) lds=32768
.amdgcn_target "amdgcn-amd-amdhsa--gfx950"
.text
.globl parallel_sum__mha_block_cached__geglu_ffn__decode_kernel
.p2align 8
.type parallel_sum__mha_block_cached__geglu_ffn__decode_kernel,@function
parallel_sum__mha_block_cached__geglu_ffn__decode_kernel:
    s_cmp_ge_u32 s2, 256
    s_cbranch_scc1 L_end
    s_memrealtime s[72:73]
    s_load_dwordx16 s[16:31], s[0:1], 0
    s_load_dwordx8 s[32:39], s[0:1], 64
    s_getpc_b64 s[12:13]
L_pc:
    s_bfe_u32 s8, s2, 0x50003
    s_lshl_b32 s8, s8, 13
    v_lshl_add_u32 v4, v0, 4, s8
    v_cmp_gt_u32 vcc, L_end-L_pc-12, v4
    s_nop 0
    s_and_saveexec_b64 s[10:11], vcc
    s_cbranch_execz L_nopf
    global_load_dwordx4 v[40:43], v4, s[12:13]
L_nopf:
    s_mov_b64 exec, -1
    v_lshrrev_b32 v2, 6, v0
    v_and_b32 v1, 63, v0
    v_readfirstlane_b32 s3, v2
    s_nop 0
    s_and_b32 s5, s2, 7
    s_lshl_b32 s5, s5, 1
    s_lshr_b32 s8, s2, 7
    s_add_u32 s5, s5, s8
    s_bfe_u32 s6, s2, 0x20003
    s_bfe_u32 s4, s2, 0x20005
    s_lshl_b32 s7, s4, 4
    s_add_u32 s7, s7, s5
    s_mov_b32 s60, 0x05040100
    s_mov_b32 s61, 0x07060302
    s_add_u32 s100, s6, 1
    s_and_b32 s100, s100, 3
    s_add_u32 s101, s6, 3
    s_and_b32 s101, s101, 3
    s_andn2_b32 s15, s5, 1
    s_lshl_b32 s64, s15, 1
    s_add_u32 s64, s64, s4
    s_add_u32 s65, s6, 1
    s_and_b32 s65, s65, 3
    s_bitcmp0_b32 s5, 0
    s_cselect_b32 s65, 0, s65
    s_cmp_ge_u32 s64, 28
    s_cselect_b32 s65, 0, s65
    s_lshr_b32 s99, s5, 2
    s_and_b32 s15, s5, 2
    s_lshl1_add_u32 s15, s15, s4
    s_lshl_b32 s15, s15, 1
    s_and_b32 s8, s5, 1
    s_mul_i32 s8, s8, 3
    s_cmp_ge_u32 s15, 14
    s_cselect_b32 s8, 0, s8
    s_cmp_eq_u32 s6, 2
    s_cselect_b32 s65, s8, s65
    s_cmp_ge_u32 s3, 4
    s_cbranch_scc1 L_helper
    v_lshlrev_b32 v2, 4, v1
    s_lshl_b32 s10, s7, 21
    s_and_b32 s8, s3, 1
    s_lshl_b32 s8, s8, 14
    s_lshr_b32 s9, s3, 1
    s_lshl_b32 s9, s9, 15
    s_add_u32 s8, s8, s9
    s_add_u32 s8, s8, s10
    s_lshl_b32 s9, s100, 10
    s_add_u32 s56, s8, s9
    s_lshl_b32 s9, s6, 7
    s_add_u32 s57, s8, s9
    s_mul_i32 s8, s5, 2
    s_mul_i32 s9, s4, 32
    s_add_u32 s8, s8, s9
    s_and_b32 s8, s8, 127
    s_lshl_b32 s8, s8, 14
    s_sub_u32 s8, s8, s10
    s_add_u32 s56, s56, s8
    s_add_u32 s57, s57, s8
    s_mov_b32 s63, 0x1fffff
    s_and_b32 s56, s56, s63
    s_and_b32 s57, s57, s63
    s_lshr_b32 s12, s2, 3
    s_lshl_b32 s12, s12, 1
    s_and_b32 s9, s3, 1
    s_add_u32 s12, s12, s9
    s_mul_i32 s12, s12, 7
    s_lshr_b32 s13, s5, 1
    s_lshl_b32 s14, s12, 13
    s_lshl_b32 s9, s13, 10
    s_add_u32 s14, s14, s9
    s_lshl_b32 s12, s12, 10
    s_mul_i32 s9, s13, 458752
    s_add_u32 s12, s12, s9
    s_movk_i32 s13, 0x400
    s_cmp_lt_u32 s3, 2
    s_cselect_b32 s12, s14, s12
    s_cselect_b32 s13, 0x2000, s13
    s_mov_b32 s50, 3670016
    s_mov_b32 s51, 0x20000
    s_mov_b32 s42, 2097152
    s_mov_b32 s43, 0x20000
    s_waitcnt lgkmcnt(0)
    s_add_u32 s40, s18, s10
    s_addc_u32 s41, s19, 0
    s_cmp_lt_u32 s3, 2
    s_cselect_b32 s48, s22, s24
    s_cselect_b32 s49, s23, s25
    buffer_load_dwordx4 v[228:231], v2, s[48:51], s12 offen
    s_add_u32 s12, s12, s13
    buffer_load_dwordx4 v[232:235], v2, s[48:51], s12 offen
    s_add_u32 s12, s12, s13
    buffer_load_dwordx4 v[236:239], v2, s[48:51], s12 offen
    s_add_u32 s12, s12, s13
    buffer_load_dwordx4 v[240:243], v2, s[48:51], s12 offen
    s_add_u32 s12, s12, s13
    buffer_load_dwordx4 v[244:247], v2, s[48:51], s12 offen
    s_add_u32 s12, s12, s13
    buffer_load_dwordx4 v[248:251], v2, s[48:51], s12 offen
    s_add_u32 s12, s12, s13
    buffer_load_dwordx4 v[252:255], v2, s[48:51], s12 offen
    s_add_u32 s44, s20, s10
    s_addc_u32 s45, s21, 0
    s_mov_b32 s46, 2097152
    s_mov_b32 s47, 0x20000
    v_lshrrev_b32 v6, 3, v1
    v_and_b32 v7, 7, v1
    v_lshlrev_b32 v3, 9, v6
    v_lshl_add_u32 v3, v7, 4, v3
    v_bfe_u32 v4, v1, 4, 1
    v_bfe_u32 v8, v1, 3, 1
    v_lshl_add_u32 v4, v8, 1, v4
    v_bfe_u32 v8, v1, 2, 1
    v_lshl_add_u32 v4, v8, 2, v4
    v_lshrrev_b32 v8, 5, v1
    v_lshl_add_u32 v4, v8, 7, v4
    v_lshlrev_b32 v4, 2, v4
    s_lshl_b32 s9, s3, 10
    s_add_u32 s9, s9, 8192
    v_add_u32 v4, s9, v4
    s_mul_i32 s9, s3, 2304
    s_add_u32 s9, s9, 12288
    v_mul_u32_u24 v5, 272, v6
    v_add_u32 v5, s9, v5
    v_bfe_u32 v9, v1, 4, 1
    v_lshl_add_u32 v8, v9, 1, v8
    v_bfe_u32 v9, v1, 3, 1
    v_lshl_add_u32 v8, v9, 2, v8
    v_lshl_add_u32 v8, v7, 3, v8
    v_lshlrev_b32 v20, 4, v8
    s_lshl_b32 s9, s3, 2
    s_add_u32 s8, s9, 1024
    v_add_u32 v20, s8, v20
    v_and_b32 v21, 31, v1
    v_lshlrev_b32 v21, 4, v21
    v_mov_b32 v22, 512
    s_add_u32 s8, s9, 512
    v_mov_b32 v23, s8
    v_mov_b32 v24, 0
    v_mov_b32 v25, 0
    v_mov_b32 v26, 0
    v_mov_b32 v27, 0
    v_mov_b32 v28, 0
    v_mov_b32 v29, 0
    v_mov_b32 v30, 0
    v_mov_b32 v31, 0
    v_mov_b32 v44, 1
    v_mov_b32 v45, 2
    s_mov_b64 vcc, 0
    s_mov_b32 s78, 0
    v_lshlrev_b32 v7, 2, v7
    s_mov_b32 s52, s36
    s_mov_b32 s53, s37
    s_mov_b32 s54, 256
    s_mov_b32 s55, 0x20000
    s_xor_b32 s58, s6, 1
    s_xor_b32 s8, s4, 1
    s_or_b32 s58, s58, s8
    s_or_b32 s58, s58, s3
    s_and_b32 s8, 1, s5
    s_or_b32 s58, s58, s8
    s_lshr_b32 s59, s5, 1
    s_lshl_b32 s59, s59, 2
    s_mov_b32 s79, 0
    s_barrier
    s_cmp_lg_u32 s58, 0
    s_cbranch_scc1 L_pb1
    s_or_b32 s8, s72, 1
    v_mov_b32 v47, s8
    s_mov_b64 exec, 1
    buffer_store_dword v47, off, s[52:55], s59 offset:0 sc1
    s_mov_b64 exec, -1
L_pb1:
    s_waitcnt vmcnt(6)
    buffer_load_dwordx4 v[48:51], v2, s[40:43], s56 offen nt
    s_addk_i32 s56, 4096
    s_waitcnt vmcnt(6)
    buffer_load_dwordx4 v[52:55], v2, s[40:43], s56 offen nt
    s_addk_i32 s56, 4096
    s_waitcnt vmcnt(6)
    buffer_load_dwordx4 v[56:59], v2, s[40:43], s56 offen nt
    s_addk_i32 s56, 4096
    s_waitcnt vmcnt(6)
    buffer_load_dwordx4 v[60:63], v2, s[40:43], s56 offen nt
    s_add_u32 s56, s56, 0xd000
    s_and_b32 s56, s56, s63
    s_waitcnt vmcnt(6)
    buffer_load_dwordx4 v[64:67], v2, s[40:43], s56 offen nt
    s_addk_i32 s56, 4096
    s_waitcnt vmcnt(4)
    buffer_load_dwordx4 v[68:71], v2, s[40:43], s56 offen nt
    s_addk_i32 s56, 4096
    s_waitcnt vmcnt(4)
    buffer_load_dwordx4 v[72:75], v2, s[40:43], s56 offen nt
    s_addk_i32 s56, 4096
    s_waitcnt vmcnt(4)
    buffer_load_dwordx4 v[76:79], v2, s[40:43], s56 offen nt
    s_add_u32 s56, s56, 0xd000
    s_and_b32 s56, s56, s63
    s_waitcnt vmcnt(4)
    buffer_load_dwordx4 v[80:83], v2, s[40:43], s56 offen nt
    s_addk_i32 s56, 4096
    s_movk_i32 s66, 560
    s_waitcnt vmcnt(4)
    buffer_load_dwordx4 v[84:87], v2, s[40:43], s56 offen nt
    s_addk_i32 s56, 4096
    s_waitcnt vmcnt(4)
    buffer_load_dwordx4 v[88:91], v2, s[40:43], s56 offen nt
    s_addk_i32 s56, 4096
    s_waitcnt vmcnt(4)
    buffer_load_dwordx4 v[92:95], v2, s[40:43], s56 offen nt
    s_add_u32 s56, s56, 0xd000
    s_and_b32 s56, s56, s63
    s_waitcnt vmcnt(4)
    buffer_load_dwordx4 v[96:99], v2, s[40:43], s56 offen nt
    s_addk_i32 s56, 4096
    s_waitcnt vmcnt(4)
    buffer_load_dwordx4 v[100:103], v2, s[40:43], s56 offen nt
    s_addk_i32 s56, 4096
    s_waitcnt vmcnt(4)
    buffer_load_dwordx4 v[104:107], v2, s[40:43], s56 offen nt
    s_addk_i32 s56, 4096
    s_waitcnt vmcnt(4)
    buffer_load_dwordx4 v[108:111], v2, s[40:43], s56 offen nt
    s_add_u32 s56, s56, 0xd000
    s_and_b32 s56, s56, s63
    s_waitcnt vmcnt(4)
    buffer_load_dwordx4 v[112:115], v2, s[40:43], s56 offen nt
    s_addk_i32 s56, 4096
    s_waitcnt vmcnt(4)
    buffer_load_dwordx4 v[116:119], v2, s[40:43], s56 offen nt
    s_addk_i32 s56, 4096
    s_waitcnt vmcnt(4)
    buffer_load_dwordx4 v[120:123], v2, s[40:43], s56 offen nt
    s_addk_i32 s56, 4096
    s_load_dwordx8 s[20:27], s[36:37], 0
    s_waitcnt vmcnt(4)
    buffer_load_dwordx4 v[124:127], v2, s[40:43], s56 offen nt
    s_add_u32 s56, s56, 0xd000
    s_and_b32 s56, s56, s63
    s_waitcnt vmcnt(4)
    buffer_load_dwordx4 v[128:131], v2, s[40:43], s56 offen nt
    s_addk_i32 s56, 4096
    s_waitcnt vmcnt(4)
    buffer_load_dwordx4 v[132:135], v2, s[40:43], s56 offen nt
    s_addk_i32 s56, 4096
    s_waitcnt vmcnt(4)
    buffer_load_dwordx4 v[136:139], v2, s[40:43], s56 offen nt
    s_addk_i32 s56, 4096
    s_waitcnt vmcnt(4)
    buffer_load_dwordx4 v[140:143], v2, s[40:43], s56 offen nt
    s_add_u32 s56, s56, 0xd000
    s_and_b32 s56, s56, s63
    s_waitcnt vmcnt(4)
    buffer_load_dwordx4 v[144:147], v2, s[40:43], s56 offen nt
    s_addk_i32 s56, 4096
    s_memrealtime s[76:77]
    s_waitcnt vmcnt(4)
    buffer_load_dwordx4 v[148:151], v2, s[40:43], s56 offen nt
    s_addk_i32 s56, 4096
    s_waitcnt lgkmcnt(0)
    s_mov_b32 s75, 0
    s_sub_u32 s8, s20, s76
    s_cmp_eq_u32 s20, 0
    s_cselect_b32 s8, 0, s8
    s_add_u32 s75, s75, s8
    s_sub_u32 s8, s21, s76
    s_cmp_eq_u32 s21, 0
    s_cselect_b32 s8, 0, s8
    s_add_u32 s75, s75, s8
    s_sub_u32 s8, s22, s76
    s_cmp_eq_u32 s22, 0
    s_cselect_b32 s8, 0, s8
    s_add_u32 s75, s75, s8
    s_sub_u32 s8, s23, s76
    s_cmp_eq_u32 s23, 0
    s_cselect_b32 s8, 0, s8
    s_add_u32 s75, s75, s8
    s_sub_u32 s8, s24, s76
    s_cmp_eq_u32 s24, 0
    s_cselect_b32 s8, 0, s8
    s_add_u32 s75, s75, s8
    s_sub_u32 s8, s25, s76
    s_cmp_eq_u32 s25, 0
    s_cselect_b32 s8, 0, s8
    s_add_u32 s75, s75, s8
    s_sub_u32 s8, s26, s76
    s_cmp_eq_u32 s26, 0
    s_cselect_b32 s8, 0, s8
    s_add_u32 s75, s75, s8
    s_sub_u32 s8, s27, s76
    s_cmp_eq_u32 s27, 0
    s_cselect_b32 s8, 0, s8
    s_add_u32 s75, s75, s8
    s_lshl_b32 s74, s76, 4
    s_lshl_b32 s75, s75, 1
    s_add_u32 s74, s74, s75
    s_add_u32 s74, s74, 3360
    s_movk_i32 s68, 224
    s_mov_b32 s69, s74
    s_mul_i32 s8, s68, 24
    s_add_u32 s74, s74, s8
    s_mul_i32 s68, s68, 4
    s_lshl_b32 s9, s76, 4
    s_sub_u32 s8, s9, s74
    s_cmp_gt_i32 s8, s66
    s_cselect_b64 vcc, -1, 0
    s_add_u32 s74, s74, s68
    s_cbranch_vccnz L_dy2
    s_waitcnt vmcnt(4)
L_dy2:
    buffer_load_dwordx4 v[152:155], v2, s[40:43], s56 offen nt
    s_addk_i32 s56, 4096
    s_cbranch_vccnz L_dy3
    s_waitcnt vmcnt(4)
L_dy3:
    buffer_load_dwordx4 v[156:159], v2, s[40:43], s56 offen nt
    s_add_u32 s56, s56, 0xd000
    s_and_b32 s56, s56, s63
    s_waitcnt vmcnt(6)
    s_cbranch_vccnz L_dy4
    s_waitcnt vmcnt(4)
L_dy4:
    buffer_load_dwordx4 v[160:163], v2, s[40:43], s56 offen nt
    s_addk_i32 s56, 4096
    s_memrealtime s[76:77]
    s_waitcnt vmcnt(6)
    s_cbranch_vccnz L_dy5
    s_waitcnt vmcnt(4)
L_dy5:
    buffer_load_dwordx4 v[164:167], v2, s[40:43], s56 offen nt
    s_addk_i32 s56, 4096
    s_waitcnt lgkmcnt(0)
    s_lshl_b32 s9, s76, 4
    s_sub_u32 s8, s9, s74
    s_cmp_gt_i32 s8, s66
    s_cselect_b64 vcc, -1, 0
    s_add_u32 s74, s74, s68
    s_waitcnt vmcnt(6)
    s_cbranch_vccnz L_dy6
    s_waitcnt vmcnt(4)
L_dy6:
    buffer_load_dwordx4 v[168:171], v2, s[40:43], s56 offen nt
    s_addk_i32 s56, 4096
    s_waitcnt vmcnt(6)
    s_cbranch_vccnz L_dy7
    s_waitcnt vmcnt(4)
L_dy7:
    buffer_load_dwordx4 v[172:175], v2, s[40:43], s56 offen nt
    s_add_u32 s56, s56, 0xd000
    s_and_b32 s56, s56, s63
    s_waitcnt vmcnt(6)
    s_cbranch_vccnz L_dy8
    s_waitcnt vmcnt(4)
L_dy8:
    buffer_load_dwordx4 v[176:179], v2, s[40:43], s56 offen nt
    s_addk_i32 s56, 4096
    s_memrealtime s[76:77]
    s_waitcnt vmcnt(6)
    s_cbranch_vccnz L_dy9
    s_waitcnt vmcnt(4)
L_dy9:
    buffer_load_dwordx4 v[180:183], v2, s[40:43], s56 offen nt
    s_addk_i32 s56, 4096
    s_waitcnt lgkmcnt(0)
    s_lshl_b32 s9, s76, 4
    s_sub_u32 s8, s9, s74
    s_cmp_gt_i32 s8, s66
    s_cselect_b64 vcc, -1, 0
    s_add_u32 s74, s74, s68
    s_waitcnt vmcnt(6)
    s_cbranch_vccnz L_dy10
    s_waitcnt vmcnt(4)
L_dy10:
    buffer_load_dwordx4 v[184:187], v2, s[40:43], s56 offen nt
    s_addk_i32 s56, 4096
    s_waitcnt vmcnt(6)
    s_cbranch_vccnz L_dy11
    s_waitcnt vmcnt(4)
L_dy11:
    buffer_load_dwordx4 v[188:191], v2, s[40:43], s56 offen nt
    s_add_u32 s56, s56, 0xd000
    s_and_b32 s56, s56, s63
    s_waitcnt vmcnt(6)
    s_cbranch_vccnz L_dy12
    s_waitcnt vmcnt(4)
L_dy12:
    buffer_load_dwordx4 v[192:195], v2, s[40:43], s56 offen nt
    s_addk_i32 s56, 4096
    s_memrealtime s[76:77]
    s_waitcnt vmcnt(6)
    s_cbranch_vccnz L_dy13
    s_waitcnt vmcnt(4)
L_dy13:
    buffer_load_dwordx4 v[196:199], v2, s[40:43], s56 offen nt
    s_addk_i32 s56, 4096
    s_waitcnt lgkmcnt(0)
    s_lshl_b32 s9, s76, 4
    s_sub_u32 s8, s9, s74
    s_cmp_gt_i32 s8, s66
    s_cselect_b64 vcc, -1, 0
    s_add_u32 s74, s74, s68
    s_waitcnt vmcnt(6)
    s_cbranch_vccnz L_dy14
    s_waitcnt vmcnt(4)
L_dy14:
    buffer_load_dwordx4 v[200:203], v2, s[40:43], s56 offen nt
    s_addk_i32 s56, 4096
    s_waitcnt vmcnt(6)
    s_cbranch_vccnz L_dy15
    s_waitcnt vmcnt(4)
L_dy15:
    buffer_load_dwordx4 v[204:207], v2, s[40:43], s56 offen nt
    s_add_u32 s56, s56, 0xd000
    s_and_b32 s56, s56, s63
    s_waitcnt vmcnt(6)
    s_cbranch_vccnz L_dy16
    s_waitcnt vmcnt(4)
L_dy16:
    buffer_load_dwordx4 v[208:211], v2, s[40:43], s56 offen nt
    s_addk_i32 s56, 4096
    ds_max_u32 v22, v44 offset:12
    s_memrealtime s[76:77]
    s_waitcnt vmcnt(6)
    s_cbranch_vccnz L_dy17
    s_waitcnt vmcnt(4)
L_dy17:
    buffer_load_dwordx4 v[212:215], v2, s[40:43], s56 offen nt
    s_addk_i32 s56, 4096
    s_waitcnt lgkmcnt(0)
    s_lshl_b32 s9, s76, 4
    s_sub_u32 s8, s9, s74
    s_cmp_gt_i32 s8, s66
    s_cselect_b64 vcc, -1, 0
    s_add_u32 s74, s74, s68
    s_waitcnt vmcnt(6)
    s_cbranch_vccnz L_dy18
    s_waitcnt vmcnt(4)
L_dy18:
    buffer_load_dwordx4 v[216:219], v2, s[40:43], s56 offen nt
    s_addk_i32 s56, 4096
    s_waitcnt vmcnt(6)
    s_cbranch_vccnz L_dy19
    s_waitcnt vmcnt(4)
L_dy19:
    buffer_load_dwordx4 v[220:223], v2, s[40:43], s56 offen nt
    s_add_u32 s56, s56, 0xd000
    s_and_b32 s56, s56, s63
    s_waitcnt vmcnt(6)
    s_cbranch_vccnz L_dy20
    s_waitcnt vmcnt(4)
L_dy20:
    buffer_load_dwordx4 v[224:227], v2, s[40:43], s56 offen nt
    s_addk_i32 s56, 4096
    s_memrealtime s[76:77]
    s_waitcnt vmcnt(6)
    s_cbranch_vccnz L_dy21
    s_waitcnt vmcnt(4)
L_dy21:
    buffer_load_dwordx4 v[228:231], v2, s[40:43], s56 offen nt
    s_addk_i32 s56, 4096
    s_waitcnt lgkmcnt(0)
    s_lshl_b32 s9, s76, 4
    s_sub_u32 s8, s9, s74
    s_cmp_gt_i32 s8, s66
    s_cselect_b64 vcc, -1, 0
    s_add_u32 s74, s74, s68
    s_waitcnt vmcnt(6)
    s_cbranch_vccnz L_dy22
    s_waitcnt vmcnt(4)
L_dy22:
    buffer_load_dwordx4 v[232:235], v2, s[40:43], s56 offen nt
    s_addk_i32 s56, 4096
    s_waitcnt vmcnt(6)
    s_cbranch_vccnz L_dy23
    s_waitcnt vmcnt(4)
L_dy23:
    buffer_load_dwordx4 v[236:239], v2, s[40:43], s56 offen nt
    s_add_u32 s56, s56, 0xd000
    s_and_b32 s56, s56, s63
    s_waitcnt vmcnt(6)
    s_cbranch_vccnz L_dy24
    s_waitcnt vmcnt(4)
L_dy24:
    buffer_load_dwordx4 v[240:243], v2, s[40:43], s56 offen nt
    s_addk_i32 s56, 4096
    s_memrealtime s[76:77]
    s_waitcnt vmcnt(6)
    s_cbranch_vccnz L_dy25
    s_waitcnt vmcnt(4)
L_dy25:
    buffer_load_dwordx4 v[244:247], v2, s[40:43], s56 offen nt
    s_addk_i32 s56, 4096
    s_waitcnt lgkmcnt(0)
    s_lshl_b32 s9, s76, 4
    s_sub_u32 s8, s9, s74
    s_cmp_gt_i32 s8, s66
    s_cselect_b64 vcc, -1, 0
    s_add_u32 s74, s74, s68
    ds_read_b32 v46, v22 offset:8
    ds_read_b128 v[8:11], v21 offset:0
    s_waitcnt vmcnt(6)
    s_cbranch_vccnz L_dy26
    s_waitcnt vmcnt(4)
L_dy26:
    buffer_load_dwordx4 v[248:251], v2, s[40:43], s56 offen nt
    s_addk_i32 s56, 4096
    s_waitcnt lgkmcnt(0)
    v_readfirstlane_b32 s8, v46
    s_nop 0
    s_cmp_eq_u32 s8, 0
    s_cbranch_scc1 L_qslow
L_qback:
    s_waitcnt vmcnt(6)
    s_cbranch_vccnz L_dy27
    s_waitcnt vmcnt(4)
L_dy27:
    buffer_load_dwordx4 v[252:255], v2, s[40:43], s56 offen nt
    s_add_u32 s56, s56, 0xd000
    s_and_b32 s56, s56, s63
    v_dot2_f32_bf16 v12, v48, v8, 0
    v_dot2_f32_bf16 v12, v49, v9, v12
    v_dot2_f32_bf16 v12, v50, v10, v12
    v_dot2_f32_bf16 v12, v51, v11, v12
    v_dot2_f32_bf16 v13, v52, v8, 0
    v_dot2_f32_bf16 v13, v53, v9, v13
    v_dot2_f32_bf16 v13, v54, v10, v13
    v_dot2_f32_bf16 v13, v55, v11, v13
    s_nop 2
    v_permlane16_swap_b32 v12, v13
    v_add_f32 v12, v12, v13
    s_waitcnt vmcnt(6)
    s_cbranch_vccnz L_dy28
    s_waitcnt vmcnt(4)
L_dy28:
    buffer_load_dwordx4 v[48:51], v2, s[40:43], s56 offen nt
    s_addk_i32 s56, 4096
    s_memrealtime s[76:77]
    v_dot2_f32_bf16 v14, v56, v8, 0
    v_dot2_f32_bf16 v14, v57, v9, v14
    v_dot2_f32_bf16 v14, v58, v10, v14
    v_dot2_f32_bf16 v14, v59, v11, v14
    v_dot2_f32_bf16 v15, v60, v8, 0
    v_dot2_f32_bf16 v15, v61, v9, v15
    v_dot2_f32_bf16 v15, v62, v10, v15
    v_dot2_f32_bf16 v15, v63, v11, v15
    s_nop 2
    v_permlane16_swap_b32 v14, v15
    v_add_f32 v14, v14, v15
    v_add_f32_dpp v13, v12, v12 row_ror:8 row_mask:0xf bank_mask:0x3
    s_nop 1
    v_add_f32_dpp v13, v14, v14 row_ror:8 row_mask:0xf bank_mask:0xc
    s_waitcnt vmcnt(6)
    s_cbranch_vccnz L_dy29
    s_waitcnt vmcnt(4)
L_dy29:
    buffer_load_dwordx4 v[52:55], v2, s[40:43], s56 offen nt
    s_addk_i32 s56, 4096
    s_waitcnt lgkmcnt(0)
    s_lshl_b32 s9, s76, 4
    s_sub_u32 s8, s9, s74
    s_cmp_gt_i32 s8, s66
    s_cselect_b64 vcc, -1, 0
    s_add_u32 s74, s74, s68
    v_dot2_f32_bf16 v16, v64, v8, 0
    v_dot2_f32_bf16 v16, v65, v9, v16
    v_dot2_f32_bf16 v16, v66, v10, v16
    v_dot2_f32_bf16 v16, v67, v11, v16
    v_dot2_f32_bf16 v17, v68, v8, 0
    v_dot2_f32_bf16 v17, v69, v9, v17
    v_dot2_f32_bf16 v17, v70, v10, v17
    v_dot2_f32_bf16 v17, v71, v11, v17
    s_nop 2
    v_permlane16_swap_b32 v16, v17
    v_add_f32 v16, v16, v17
    s_waitcnt vmcnt(6)
    s_cbranch_vccnz L_dy30
    s_waitcnt vmcnt(4)
L_dy30:
    buffer_load_dwordx4 v[56:59], v2, s[40:43], s56 offen nt
    s_addk_i32 s56, 4096
    v_dot2_f32_bf16 v18, v72, v8, 0
    v_dot2_f32_bf16 v18, v73, v9, v18
    v_dot2_f32_bf16 v18, v74, v10, v18
    v_dot2_f32_bf16 v18, v75, v11, v18
    v_dot2_f32_bf16 v19, v76, v8, 0
    v_dot2_f32_bf16 v19, v77, v9, v19
    v_dot2_f32_bf16 v19, v78, v10, v19
    v_dot2_f32_bf16 v19, v79, v11, v19
    s_nop 2
    v_permlane16_swap_b32 v18, v19
    v_add_f32 v18, v18, v19
    v_add_f32_dpp v17, v16, v16 row_ror:8 row_mask:0xf bank_mask:0x3
    s_nop 1
    v_add_f32_dpp v17, v18, v18 row_ror:8 row_mask:0xf bank_mask:0xc
    v_add_f32_dpp v15, v13, v13 row_half_mirror row_mask:0xf bank_mask:0x5
    s_nop 1
    v_add_f32_dpp v15, v17, v17 row_half_mirror row_mask:0xf bank_mask:0xa
    s_nop 1
    v_add_f32_dpp v15, v15, v15 quad_perm:[1,0,3,2] row_mask:0xf bank_mask:0xf
    s_nop 1
    v_add_f32_dpp v15, v15, v15 quad_perm:[2,3,0,1] row_mask:0xf bank_mask:0xf
    ds_write_b32 v4, v15 offset:0
    s_waitcnt vmcnt(6)
    s_cbranch_vccnz L_dy31
    s_waitcnt vmcnt(4)
L_dy31:
    buffer_load_dwordx4 v[60:63], v2, s[40:43], s56 offen nt
    s_add_u32 s56, s56, 0xd000
    s_and_b32 s56, s56, s63
    v_dot2_f32_bf16 v12, v80, v8, 0
    v_dot2_f32_bf16 v12, v81, v9, v12
    v_dot2_f32_bf16 v12, v82, v10, v12
    v_dot2_f32_bf16 v12, v83, v11, v12
    v_dot2_f32_bf16 v13, v84, v8, 0
    v_dot2_f32_bf16 v13, v85, v9, v13
    v_dot2_f32_bf16 v13, v86, v10, v13
    v_dot2_f32_bf16 v13, v87, v11, v13
    s_nop 2
    v_permlane16_swap_b32 v12, v13
    v_add_f32 v12, v12, v13
    s_waitcnt vmcnt(6)
    s_cbranch_vccnz L_dy32
    s_waitcnt vmcnt(4)
L_dy32:
    buffer_load_dwordx4 v[64:67], v2, s[40:43], s56 offen nt
    s_addk_i32 s56, 4096
    s_memrealtime s[76:77]
    v_dot2_f32_bf16 v14, v88, v8, 0
    v_dot2_f32_bf16 v14, v89, v9, v14
    v_dot2_f32_bf16 v14, v90, v10, v14
    v_dot2_f32_bf16 v14, v91, v11, v14
    v_dot2_f32_bf16 v15, v92, v8, 0
    v_dot2_f32_bf16 v15, v93, v9, v15
    v_dot2_f32_bf16 v15, v94, v10, v15
    v_dot2_f32_bf16 v15, v95, v11, v15
    s_nop 2
    v_permlane16_swap_b32 v14, v15
    v_add_f32 v14, v14, v15
    v_add_f32_dpp v13, v12, v12 row_ror:8 row_mask:0xf bank_mask:0x3
    s_nop 1
    v_add_f32_dpp v13, v14, v14 row_ror:8 row_mask:0xf bank_mask:0xc
    s_waitcnt vmcnt(6)
    s_cbranch_vccnz L_dy33
    s_waitcnt vmcnt(4)
L_dy33:
    buffer_load_dwordx4 v[68:71], v2, s[40:43], s56 offen nt
    s_addk_i32 s56, 4096
    s_waitcnt lgkmcnt(0)
    s_lshl_b32 s9, s76, 4
    s_sub_u32 s8, s9, s74
    s_cmp_gt_i32 s8, s66
    s_cselect_b64 vcc, -1, 0
    s_add_u32 s74, s74, s68
    v_dot2_f32_bf16 v16, v96, v8, 0
    v_dot2_f32_bf16 v16, v97, v9, v16
    v_dot2_f32_bf16 v16, v98, v10, v16
    v_dot2_f32_bf16 v16, v99, v11, v16
    v_dot2_f32_bf16 v17, v100, v8, 0
    v_dot2_f32_bf16 v17, v101, v9, v17
    v_dot2_f32_bf16 v17, v102, v10, v17
    v_dot2_f32_bf16 v17, v103, v11, v17
    s_nop 2
    v_permlane16_swap_b32 v16, v17
    v_add_f32 v16, v16, v17
    s_waitcnt vmcnt(6)
    s_cbranch_vccnz L_dy34
    s_waitcnt vmcnt(4)
L_dy34:
    buffer_load_dwordx4 v[72:75], v2, s[40:43], s56 offen nt
    s_addk_i32 s56, 4096
    v_dot2_f32_bf16 v18, v104, v8, 0
    v_dot2_f32_bf16 v18, v105, v9, v18
    v_dot2_f32_bf16 v18, v106, v10, v18
    v_dot2_f32_bf16 v18, v107, v11, v18
    v_dot2_f32_bf16 v19, v108, v8, 0
    v_dot2_f32_bf16 v19, v109, v9, v19
    v_dot2_f32_bf16 v19, v110, v10, v19
    v_dot2_f32_bf16 v19, v111, v11, v19
    s_nop 2
    v_permlane16_swap_b32 v18, v19
    v_add_f32 v18, v18, v19
    v_add_f32_dpp v17, v16, v16 row_ror:8 row_mask:0xf bank_mask:0x3
    s_nop 1
    v_add_f32_dpp v17, v18, v18 row_ror:8 row_mask:0xf bank_mask:0xc
    v_add_f32_dpp v15, v13, v13 row_half_mirror row_mask:0xf bank_mask:0x5
    s_nop 1
    v_add_f32_dpp v15, v17, v17 row_half_mirror row_mask:0xf bank_mask:0xa
    s_nop 1
    v_add_f32_dpp v15, v15, v15 quad_perm:[1,0,3,2] row_mask:0xf bank_mask:0xf
    s_nop 1
    v_add_f32_dpp v15, v15, v15 quad_perm:[2,3,0,1] row_mask:0xf bank_mask:0xf
    ds_write_b32 v4, v15 offset:32
    s_waitcnt vmcnt(6)
    s_cbranch_vccnz L_dy35
    s_waitcnt vmcnt(4)
L_dy35:
    buffer_load_dwordx4 v[76:79], v2, s[40:43], s56 offen nt
    s_add_u32 s56, s56, 0xd000
    s_and_b32 s56, s56, s63
    v_dot2_f32_bf16 v12, v112, v8, 0
    v_dot2_f32_bf16 v12, v113, v9, v12
    v_dot2_f32_bf16 v12, v114, v10, v12
    v_dot2_f32_bf16 v12, v115, v11, v12
    v_dot2_f32_bf16 v13, v116, v8, 0
    v_dot2_f32_bf16 v13, v117, v9, v13
    v_dot2_f32_bf16 v13, v118, v10, v13
    v_dot2_f32_bf16 v13, v119, v11, v13
    s_nop 2
    v_permlane16_swap_b32 v12, v13
    v_add_f32 v12, v12, v13
    s_waitcnt vmcnt(6)
    s_cbranch_vccnz L_dy36
    s_waitcnt vmcnt(4)
L_dy36:
    buffer_load_dwordx4 v[80:83], v2, s[40:43], s56 offen nt
    s_addk_i32 s56, 4096
    s_memrealtime s[76:77]
    v_dot2_f32_bf16 v14, v120, v8, 0
    v_dot2_f32_bf16 v14, v121, v9, v14
    v_dot2_f32_bf16 v14, v122, v10, v14
    v_dot2_f32_bf16 v14, v123, v11, v14
    v_dot2_f32_bf16 v15, v124, v8, 0
    v_dot2_f32_bf16 v15, v125, v9, v15
    v_dot2_f32_bf16 v15, v126, v10, v15
    v_dot2_f32_bf16 v15, v127, v11, v15
    s_nop 2
    v_permlane16_swap_b32 v14, v15
    v_add_f32 v14, v14, v15
    v_add_f32_dpp v13, v12, v12 row_ror:8 row_mask:0xf bank_mask:0x3
    s_nop 1
    v_add_f32_dpp v13, v14, v14 row_ror:8 row_mask:0xf bank_mask:0xc
    s_waitcnt vmcnt(6)
    s_cbranch_vccnz L_dy37
    s_waitcnt vmcnt(4)
L_dy37:
    buffer_load_dwordx4 v[84:87], v2, s[40:43], s56 offen nt
    s_addk_i32 s56, 4096
    s_waitcnt lgkmcnt(0)
    s_lshl_b32 s9, s76, 4
    s_sub_u32 s8, s9, s74
    s_cmp_gt_i32 s8, s66
    s_cselect_b64 vcc, -1, 0
    s_add_u32 s74, s74, s68
    v_dot2_f32_bf16 v16, v128, v8, 0
    v_dot2_f32_bf16 v16, v129, v9, v16
    v_dot2_f32_bf16 v16, v130, v10, v16
    v_dot2_f32_bf16 v16, v131, v11, v16
    v_dot2_f32_bf16 v17, v132, v8, 0
    v_dot2_f32_bf16 v17, v133, v9, v17
    v_dot2_f32_bf16 v17, v134, v10, v17
    v_dot2_f32_bf16 v17, v135, v11, v17
    s_nop 2
    v_permlane16_swap_b32 v16, v17
    v_add_f32 v16, v16, v17
    s_waitcnt vmcnt(6)
    s_cbranch_vccnz L_dy38
    s_waitcnt vmcnt(4)
L_dy38:
    buffer_load_dwordx4 v[88:91], v2, s[40:43], s56 offen nt
    s_addk_i32 s56, 4096
    v_dot2_f32_bf16 v18, v136, v8, 0
    v_dot2_f32_bf16 v18, v137, v9, v18
    v_dot2_f32_bf16 v18, v138, v10, v18
    v_dot2_f32_bf16 v18, v139, v11, v18
    v_dot2_f32_bf16 v19, v140, v8, 0
    v_dot2_f32_bf16 v19, v141, v9, v19
    v_dot2_f32_bf16 v19, v142, v10, v19
    v_dot2_f32_bf16 v19, v143, v11, v19
    s_nop 2
    v_permlane16_swap_b32 v18, v19
    v_add_f32 v18, v18, v19
    v_add_f32_dpp v17, v16, v16 row_ror:8 row_mask:0xf bank_mask:0x3
    s_nop 1
    v_add_f32_dpp v17, v18, v18 row_ror:8 row_mask:0xf bank_mask:0xc
    v_add_f32_dpp v15, v13, v13 row_half_mirror row_mask:0xf bank_mask:0x5
    s_nop 1
    v_add_f32_dpp v15, v17, v17 row_half_mirror row_mask:0xf bank_mask:0xa
    s_nop 1
    v_add_f32_dpp v15, v15, v15 quad_perm:[1,0,3,2] row_mask:0xf bank_mask:0xf
    s_nop 1
    v_add_f32_dpp v15, v15, v15 quad_perm:[2,3,0,1] row_mask:0xf bank_mask:0xf
    ds_write_b32 v4, v15 offset:64
    s_waitcnt vmcnt(6)
    s_cbranch_vccnz L_dy39
    s_waitcnt vmcnt(4)
L_dy39:
    buffer_load_dwordx4 v[92:95], v2, s[40:43], s56 offen nt
    s_add_u32 s56, s56, 0xd000
    s_and_b32 s56, s56, s63
    v_dot2_f32_bf16 v12, v144, v8, 0
    v_dot2_f32_bf16 v12, v145, v9, v12
    v_dot2_f32_bf16 v12, v146, v10, v12
    v_dot2_f32_bf16 v12, v147, v11, v12
    v_dot2_f32_bf16 v13, v148, v8, 0
    v_dot2_f32_bf16 v13, v149, v9, v13
    v_dot2_f32_bf16 v13, v150, v10, v13
    v_dot2_f32_bf16 v13, v151, v11, v13
    s_nop 2
    v_permlane16_swap_b32 v12, v13
    v_add_f32 v12, v12, v13
    s_waitcnt vmcnt(6)
    s_cbranch_vccnz L_dy40
    s_waitcnt vmcnt(4)
L_dy40:
    buffer_load_dwordx4 v[96:99], v2, s[40:43], s56 offen nt
    s_addk_i32 s56, 4096
    s_memrealtime s[76:77]
    v_dot2_f32_bf16 v14, v152, v8, 0
    v_dot2_f32_bf16 v14, v153, v9, v14
    v_dot2_f32_bf16 v14, v154, v10, v14
    v_dot2_f32_bf16 v14, v155, v11, v14
    v_dot2_f32_bf16 v15, v156, v8, 0
    v_dot2_f32_bf16 v15, v157, v9, v15
    v_dot2_f32_bf16 v15, v158, v10, v15
    v_dot2_f32_bf16 v15, v159, v11, v15
    s_nop 2
    v_permlane16_swap_b32 v14, v15
    v_add_f32 v14, v14, v15
    v_add_f32_dpp v13, v12, v12 row_ror:8 row_mask:0xf bank_mask:0x3
    s_nop 1
    v_add_f32_dpp v13, v14, v14 row_ror:8 row_mask:0xf bank_mask:0xc
    s_waitcnt vmcnt(6)
    s_cbranch_vccnz L_dy41
    s_waitcnt vmcnt(4)
L_dy41:
    buffer_load_dwordx4 v[100:103], v2, s[40:43], s56 offen nt
    s_addk_i32 s56, 4096
    s_waitcnt lgkmcnt(0)
    s_cmp_lg_u32 s58, 0
    s_cbranch_scc1 L_pb42
    s_or_b32 s8, s76, 1
    v_mov_b32 v47, s8
    s_mov_b64 exec, 1
    buffer_store_dword v47, off, s[52:55], s59 offset:128 sc1
    s_mov_b64 exec, -1
L_pb42:
    s_lshl_b32 s9, s76, 4
    s_sub_u32 s8, s9, s74
    s_cmp_gt_i32 s8, s66
    s_cselect_b64 vcc, -1, 0
    s_add_u32 s74, s74, s68
    v_dot2_f32_bf16 v16, v160, v8, 0
    v_dot2_f32_bf16 v16, v161, v9, v16
    v_dot2_f32_bf16 v16, v162, v10, v16
    v_dot2_f32_bf16 v16, v163, v11, v16
    v_dot2_f32_bf16 v17, v164, v8, 0
    v_dot2_f32_bf16 v17, v165, v9, v17
    v_dot2_f32_bf16 v17, v166, v10, v17
    v_dot2_f32_bf16 v17, v167, v11, v17
    s_nop 2
    v_permlane16_swap_b32 v16, v17
    v_add_f32 v16, v16, v17
    s_waitcnt vmcnt(6)
    s_cbranch_vccnz L_dy43
    s_waitcnt vmcnt(4)
L_dy43:
    buffer_load_dwordx4 v[104:107], v2, s[40:43], s56 offen nt
    s_addk_i32 s56, 4096
    v_dot2_f32_bf16 v18, v168, v8, 0
    v_dot2_f32_bf16 v18, v169, v9, v18
    v_dot2_f32_bf16 v18, v170, v10, v18
    v_dot2_f32_bf16 v18, v171, v11, v18
    v_dot2_f32_bf16 v19, v172, v8, 0
    v_dot2_f32_bf16 v19, v173, v9, v19
    v_dot2_f32_bf16 v19, v174, v10, v19
    v_dot2_f32_bf16 v19, v175, v11, v19
    s_nop 2
    v_permlane16_swap_b32 v18, v19
    v_add_f32 v18, v18, v19
    v_add_f32_dpp v17, v16, v16 row_ror:8 row_mask:0xf bank_mask:0x3
    s_nop 1
    v_add_f32_dpp v17, v18, v18 row_ror:8 row_mask:0xf bank_mask:0xc
    v_add_f32_dpp v15, v13, v13 row_half_mirror row_mask:0xf bank_mask:0x5
    s_nop 1
    v_add_f32_dpp v15, v17, v17 row_half_mirror row_mask:0xf bank_mask:0xa
    s_nop 1
    v_add_f32_dpp v15, v15, v15 quad_perm:[1,0,3,2] row_mask:0xf bank_mask:0xf
    s_nop 1
    v_add_f32_dpp v15, v15, v15 quad_perm:[2,3,0,1] row_mask:0xf bank_mask:0xf
    ds_write_b32 v4, v15 offset:96
    s_waitcnt vmcnt(6)
    s_cbranch_vccnz L_dy44
    s_waitcnt vmcnt(4)
L_dy44:
    buffer_load_dwordx4 v[108:111], v2, s[40:43], s56 offen nt
    s_add_u32 s56, s56, 0xd000
    s_and_b32 s56, s56, s63
    v_dot2_f32_bf16 v12, v176, v8, 0
    v_dot2_f32_bf16 v12, v177, v9, v12
    v_dot2_f32_bf16 v12, v178, v10, v12
    v_dot2_f32_bf16 v12, v179, v11, v12
    v_dot2_f32_bf16 v13, v180, v8, 0
    v_dot2_f32_bf16 v13, v181, v9, v13
    v_dot2_f32_bf16 v13, v182, v10, v13
    v_dot2_f32_bf16 v13, v183, v11, v13
    s_nop 2
    v_permlane16_swap_b32 v12, v13
    v_add_f32 v12, v12, v13
    s_waitcnt vmcnt(6)
    s_cbranch_vccnz L_dy45
    s_waitcnt vmcnt(4)
L_dy45:
    buffer_load_dwordx4 v[112:115], v2, s[40:43], s56 offen nt
    s_addk_i32 s56, 4096
    s_memrealtime s[76:77]
    v_dot2_f32_bf16 v14, v184, v8, 0
    v_dot2_f32_bf16 v14, v185, v9, v14
    v_dot2_f32_bf16 v14, v186, v10, v14
    v_dot2_f32_bf16 v14, v187, v11, v14
    v_dot2_f32_bf16 v15, v188, v8, 0
    v_dot2_f32_bf16 v15, v189, v9, v15
    v_dot2_f32_bf16 v15, v190, v10, v15
    v_dot2_f32_bf16 v15, v191, v11, v15
    s_nop 2
    v_permlane16_swap_b32 v14, v15
    v_add_f32 v14, v14, v15
    v_add_f32_dpp v13, v12, v12 row_ror:8 row_mask:0xf bank_mask:0x3
    s_nop 1
    v_add_f32_dpp v13, v14, v14 row_ror:8 row_mask:0xf bank_mask:0xc
    s_waitcnt vmcnt(6)
    s_cbranch_vccnz L_dy46
    s_waitcnt vmcnt(4)
L_dy46:
    buffer_load_dwordx4 v[116:119], v2, s[40:43], s56 offen nt
    s_addk_i32 s56, 4096
    s_waitcnt lgkmcnt(0)
    s_lshl_b32 s9, s76, 4
    s_sub_u32 s8, s9, s74
    s_cmp_gt_i32 s8, s66
    s_cselect_b64 vcc, -1, 0
    s_add_u32 s74, s74, s68
    v_dot2_f32_bf16 v16, v192, v8, 0
    v_dot2_f32_bf16 v16, v193, v9, v16
    v_dot2_f32_bf16 v16, v194, v10, v16
    v_dot2_f32_bf16 v16, v195, v11, v16
    v_dot2_f32_bf16 v17, v196, v8, 0
    v_dot2_f32_bf16 v17, v197, v9, v17
    v_dot2_f32_bf16 v17, v198, v10, v17
    v_dot2_f32_bf16 v17, v199, v11, v17
    s_nop 2
    v_permlane16_swap_b32 v16, v17
    v_add_f32 v16, v16, v17
    s_waitcnt vmcnt(6)
    s_cbranch_vccnz L_dy47
    s_waitcnt vmcnt(4)
L_dy47:
    buffer_load_dwordx4 v[120:123], v2, s[40:43], s56 offen nt
    s_addk_i32 s56, 4096
    v_dot2_f32_bf16 v18, v200, v8, 0
    v_dot2_f32_bf16 v18, v201, v9, v18
    v_dot2_f32_bf16 v18, v202, v10, v18
    v_dot2_f32_bf16 v18, v203, v11, v18
    v_dot2_f32_bf16 v19, v204, v8, 0
    v_dot2_f32_bf16 v19, v205, v9, v19
    v_dot2_f32_bf16 v19, v206, v10, v19
    v_dot2_f32_bf16 v19, v207, v11, v19
    s_nop 2
    v_permlane16_swap_b32 v18, v19
    v_add_f32 v18, v18, v19
    v_add_f32_dpp v17, v16, v16 row_ror:8 row_mask:0xf bank_mask:0x3
    s_nop 1
    v_add_f32_dpp v17, v18, v18 row_ror:8 row_mask:0xf bank_mask:0xc
    v_add_f32_dpp v15, v13, v13 row_half_mirror row_mask:0xf bank_mask:0x5
    s_nop 1
    v_add_f32_dpp v15, v17, v17 row_half_mirror row_mask:0xf bank_mask:0xa
    s_nop 1
    v_add_f32_dpp v15, v15, v15 quad_perm:[1,0,3,2] row_mask:0xf bank_mask:0xf
    s_nop 1
    v_add_f32_dpp v15, v15, v15 quad_perm:[2,3,0,1] row_mask:0xf bank_mask:0xf
    ds_write_b32 v4, v15 offset:128
    s_waitcnt vmcnt(6)
    s_cbranch_vccnz L_dy48
    s_waitcnt vmcnt(4)
L_dy48:
    buffer_load_dwordx4 v[124:127], v2, s[40:43], s56 offen nt
    s_add_u32 s56, s56, 0xd000
    s_and_b32 s56, s56, s63
    v_dot2_f32_bf16 v12, v208, v8, 0
    v_dot2_f32_bf16 v12, v209, v9, v12
    v_dot2_f32_bf16 v12, v210, v10, v12
    v_dot2_f32_bf16 v12, v211, v11, v12
    v_dot2_f32_bf16 v13, v212, v8, 0
    v_dot2_f32_bf16 v13, v213, v9, v13
    v_dot2_f32_bf16 v13, v214, v10, v13
    v_dot2_f32_bf16 v13, v215, v11, v13
    s_nop 2
    v_permlane16_swap_b32 v12, v13
    v_add_f32 v12, v12, v13
    s_waitcnt vmcnt(6)
    s_cbranch_vccnz L_dy49
    s_waitcnt vmcnt(4)
L_dy49:
    buffer_load_dwordx4 v[128:131], v2, s[40:43], s56 offen nt
    s_addk_i32 s56, 4096
    ds_max_u32 v22, v45 offset:12
    s_memrealtime s[76:77]
    v_dot2_f32_bf16 v14, v216, v8, 0
    v_dot2_f32_bf16 v14, v217, v9, v14
    v_dot2_f32_bf16 v14, v218, v10, v14
    v_dot2_f32_bf16 v14, v219, v11, v14
    v_dot2_f32_bf16 v15, v220, v8, 0
    v_dot2_f32_bf16 v15, v221, v9, v15
    v_dot2_f32_bf16 v15, v222, v10, v15
    v_dot2_f32_bf16 v15, v223, v11, v15
    s_nop 2
    v_permlane16_swap_b32 v14, v15
    v_add_f32 v14, v14, v15
    v_add_f32_dpp v13, v12, v12 row_ror:8 row_mask:0xf bank_mask:0x3
    s_nop 1
    v_add_f32_dpp v13, v14, v14 row_ror:8 row_mask:0xf bank_mask:0xc
    s_waitcnt vmcnt(6)
    s_cbranch_vccnz L_dy50
    s_waitcnt vmcnt(4)
L_dy50:
    buffer_load_dwordx4 v[132:135], v2, s[40:43], s56 offen nt
    s_addk_i32 s56, 4096
    s_waitcnt lgkmcnt(0)
    s_lshl_b32 s9, s76, 4
    s_sub_u32 s8, s9, s74
    s_cmp_gt_i32 s8, s66
    s_cselect_b64 vcc, -1, 0
    s_add_u32 s74, s74, s68
    v_dot2_f32_bf16 v16, v224, v8, 0
    v_dot2_f32_bf16 v16, v225, v9, v16
    v_dot2_f32_bf16 v16, v226, v10, v16
    v_dot2_f32_bf16 v16, v227, v11, v16
    v_dot2_f32_bf16 v17, v228, v8, 0
    v_dot2_f32_bf16 v17, v229, v9, v17
    v_dot2_f32_bf16 v17, v230, v10, v17
    v_dot2_f32_bf16 v17, v231, v11, v17
    s_nop 2
    v_permlane16_swap_b32 v16, v17
    v_add_f32 v16, v16, v17
    s_waitcnt vmcnt(6)
    s_cbranch_vccnz L_dy51
    s_waitcnt vmcnt(4)
L_dy51:
    buffer_load_dwordx4 v[136:139], v2, s[40:43], s56 offen nt
    s_addk_i32 s56, 4096
    v_dot2_f32_bf16 v18, v232, v8, 0
    v_dot2_f32_bf16 v18, v233, v9, v18
    v_dot2_f32_bf16 v18, v234, v10, v18
    v_dot2_f32_bf16 v18, v235, v11, v18
    v_dot2_f32_bf16 v19, v236, v8, 0
    v_dot2_f32_bf16 v19, v237, v9, v19
    v_dot2_f32_bf16 v19, v238, v10, v19
    v_dot2_f32_bf16 v19, v239, v11, v19
    s_nop 2
    v_permlane16_swap_b32 v18, v19
    v_add_f32 v18, v18, v19
    v_add_f32_dpp v17, v16, v16 row_ror:8 row_mask:0xf bank_mask:0x3
    s_nop 1
    v_add_f32_dpp v17, v18, v18 row_ror:8 row_mask:0xf bank_mask:0xc
    v_add_f32_dpp v15, v13, v13 row_half_mirror row_mask:0xf bank_mask:0x5
    s_nop 1
    v_add_f32_dpp v15, v17, v17 row_half_mirror row_mask:0xf bank_mask:0xa
    s_nop 1
    v_add_f32_dpp v15, v15, v15 quad_perm:[1,0,3,2] row_mask:0xf bank_mask:0xf
    s_nop 1
    v_add_f32_dpp v15, v15, v15 quad_perm:[2,3,0,1] row_mask:0xf bank_mask:0xf
    ds_write_b32 v4, v15 offset:160
    s_waitcnt vmcnt(6)
    s_cbranch_vccnz L_dy52
    s_waitcnt vmcnt(4)
L_dy52:
    buffer_load_dwordx4 v[140:143], v2, s[40:43], s56 offen nt
    s_add_u32 s56, s56, 0xd000
    s_and_b32 s56, s56, s63
    v_dot2_f32_bf16 v12, v240, v8, 0
    v_dot2_f32_bf16 v12, v241, v9, v12
    v_dot2_f32_bf16 v12, v242, v10, v12
    v_dot2_f32_bf16 v12, v243, v11, v12
    v_dot2_f32_bf16 v13, v244, v8, 0
    v_dot2_f32_bf16 v13, v245, v9, v13
    v_dot2_f32_bf16 v13, v246, v10, v13
    v_dot2_f32_bf16 v13, v247, v11, v13
    s_nop 2
    v_permlane16_swap_b32 v12, v13
    v_add_f32 v12, v12, v13
    s_waitcnt vmcnt(6)
    s_cbranch_vccnz L_dy53
    s_waitcnt vmcnt(4)
L_dy53:
    buffer_load_dwordx4 v[144:147], v2, s[40:43], s56 offen nt
    s_addk_i32 s56, 4096
    s_memrealtime s[76:77]
    v_dot2_f32_bf16 v14, v248, v8, 0
    v_dot2_f32_bf16 v14, v249, v9, v14
    v_dot2_f32_bf16 v14, v250, v10, v14
    v_dot2_f32_bf16 v14, v251, v11, v14
    v_dot2_f32_bf16 v15, v252, v8, 0
    v_dot2_f32_bf16 v15, v253, v9, v15
    v_dot2_f32_bf16 v15, v254, v10, v15
    v_dot2_f32_bf16 v15, v255, v11, v15
    s_nop 2
    v_permlane16_swap_b32 v14, v15
    v_add_f32 v14, v14, v15
    v_add_f32_dpp v13, v12, v12 row_ror:8 row_mask:0xf bank_mask:0x3
    s_nop 1
    v_add_f32_dpp v13, v14, v14 row_ror:8 row_mask:0xf bank_mask:0xc
    s_waitcnt vmcnt(6)
    s_cbranch_vccnz L_dy54
    s_waitcnt vmcnt(4)
L_dy54:
    buffer_load_dwordx4 v[148:151], v2, s[40:43], s56 offen nt
    s_addk_i32 s56, 4096
    s_waitcnt lgkmcnt(0)
    s_lshl_b32 s9, s76, 4
    s_sub_u32 s8, s9, s74
    s_cmp_gt_i32 s8, s66
    s_cselect_b64 vcc, -1, 0
    s_add_u32 s74, s74, s68
    v_dot2_f32_bf16 v16, v48, v8, 0
    v_dot2_f32_bf16 v16, v49, v9, v16
    v_dot2_f32_bf16 v16, v50, v10, v16
    v_dot2_f32_bf16 v16, v51, v11, v16
    v_dot2_f32_bf16 v17, v52, v8, 0
    v_dot2_f32_bf16 v17, v53, v9, v17
    v_dot2_f32_bf16 v17, v54, v10, v17
    v_dot2_f32_bf16 v17, v55, v11, v17
    s_nop 2
    v_permlane16_swap_b32 v16, v17
    v_add_f32 v16, v16, v17
    s_waitcnt vmcnt(6)
    s_cbranch_vccnz L_dy55
    s_waitcnt vmcnt(4)
L_dy55:
    buffer_load_dwordx4 v[152:155], v2, s[40:43], s56 offen nt
    s_addk_i32 s56, 4096
    v_dot2_f32_bf16 v18, v56, v8, 0
    v_dot2_f32_bf16 v18, v57, v9, v18
    v_dot2_f32_bf16 v18, v58, v10, v18
    v_dot2_f32_bf16 v18, v59, v11, v18
    v_dot2_f32_bf16 v19, v60, v8, 0
    v_dot2_f32_bf16 v19, v61, v9, v19
    v_dot2_f32_bf16 v19, v62, v10, v19
    v_dot2_f32_bf16 v19, v63, v11, v19
    s_nop 2
    v_permlane16_swap_b32 v18, v19
    v_add_f32 v18, v18, v19
    v_add_f32_dpp v17, v16, v16 row_ror:8 row_mask:0xf bank_mask:0x3
    s_nop 1
    v_add_f32_dpp v17, v18, v18 row_ror:8 row_mask:0xf bank_mask:0xc
    v_add_f32_dpp v15, v13, v13 row_half_mirror row_mask:0xf bank_mask:0x5
    s_nop 1
    v_add_f32_dpp v15, v17, v17 row_half_mirror row_mask:0xf bank_mask:0xa
    s_nop 1
    v_add_f32_dpp v15, v15, v15 quad_perm:[1,0,3,2] row_mask:0xf bank_mask:0xf
    s_nop 1
    v_add_f32_dpp v15, v15, v15 quad_perm:[2,3,0,1] row_mask:0xf bank_mask:0xf
    ds_write_b32 v4, v15 offset:192
    s_waitcnt vmcnt(6)
    s_cbranch_vccnz L_dy56
    s_waitcnt vmcnt(4)
L_dy56:
    buffer_load_dwordx4 v[156:159], v2, s[40:43], s56 offen nt
    s_add_u32 s56, s56, 0xd000
    s_and_b32 s56, s56, s63
    v_dot2_f32_bf16 v12, v64, v8, 0
    v_dot2_f32_bf16 v12, v65, v9, v12
    v_dot2_f32_bf16 v12, v66, v10, v12
    v_dot2_f32_bf16 v12, v67, v11, v12
    v_dot2_f32_bf16 v13, v68, v8, 0
    v_dot2_f32_bf16 v13, v69, v9, v13
    v_dot2_f32_bf16 v13, v70, v10, v13
    v_dot2_f32_bf16 v13, v71, v11, v13
    s_nop 2
    v_permlane16_swap_b32 v12, v13
    v_add_f32 v12, v12, v13
    s_waitcnt vmcnt(6)
    s_cbranch_vccnz L_dy57
    s_waitcnt vmcnt(4)
L_dy57:
    buffer_load_dwordx4 v[160:163], v2, s[40:43], s56 offen nt
    s_addk_i32 s56, 4096
    s_memrealtime s[76:77]
    v_dot2_f32_bf16 v14, v72, v8, 0
    v_dot2_f32_bf16 v14, v73, v9, v14
    v_dot2_f32_bf16 v14, v74, v10, v14
    v_dot2_f32_bf16 v14, v75, v11, v14
    v_dot2_f32_bf16 v15, v76, v8, 0
    v_dot2_f32_bf16 v15, v77, v9, v15
    v_dot2_f32_bf16 v15, v78, v10, v15
    v_dot2_f32_bf16 v15, v79, v11, v15
    s_nop 2
    v_permlane16_swap_b32 v14, v15
    v_add_f32 v14, v14, v15
    v_add_f32_dpp v13, v12, v12 row_ror:8 row_mask:0xf bank_mask:0x3
    s_nop 1
    v_add_f32_dpp v13, v14, v14 row_ror:8 row_mask:0xf bank_mask:0xc
    s_waitcnt vmcnt(6)
    s_cbranch_vccnz L_dy58
    s_waitcnt vmcnt(4)
L_dy58:
    buffer_load_dwordx4 v[164:167], v2, s[40:43], s56 offen nt
    s_addk_i32 s56, 4096
    s_waitcnt lgkmcnt(0)
    s_lshl_b32 s9, s76, 4
    s_sub_u32 s8, s9, s74
    s_cmp_gt_i32 s8, s66
    s_cselect_b64 vcc, -1, 0
    s_add_u32 s74, s74, s68
    v_dot2_f32_bf16 v16, v80, v8, 0
    v_dot2_f32_bf16 v16, v81, v9, v16
    v_dot2_f32_bf16 v16, v82, v10, v16
    v_dot2_f32_bf16 v16, v83, v11, v16
    v_dot2_f32_bf16 v17, v84, v8, 0
    v_dot2_f32_bf16 v17, v85, v9, v17
    v_dot2_f32_bf16 v17, v86, v10, v17
    v_dot2_f32_bf16 v17, v87, v11, v17
    s_nop 2
    v_permlane16_swap_b32 v16, v17
    v_add_f32 v16, v16, v17
    s_waitcnt vmcnt(6)
    s_cbranch_vccnz L_dy59
    s_waitcnt vmcnt(4)
L_dy59:
    buffer_load_dwordx4 v[168:171], v2, s[40:43], s56 offen nt
    s_addk_i32 s56, 4096
    s_load_dwordx8 s[20:27], s[36:37], 128
    v_dot2_f32_bf16 v18, v88, v8, 0
    v_dot2_f32_bf16 v18, v89, v9, v18
    v_dot2_f32_bf16 v18, v90, v10, v18
    v_dot2_f32_bf16 v18, v91, v11, v18
    v_dot2_f32_bf16 v19, v92, v8, 0
    v_dot2_f32_bf16 v19, v93, v9, v19
    v_dot2_f32_bf16 v19, v94, v10, v19
    v_dot2_f32_bf16 v19, v95, v11, v19
    s_nop 2
    v_permlane16_swap_b32 v18, v19
    v_add_f32 v18, v18, v19
    v_add_f32_dpp v17, v16, v16 row_ror:8 row_mask:0xf bank_mask:0x3
    s_nop 1
    v_add_f32_dpp v17, v18, v18 row_ror:8 row_mask:0xf bank_mask:0xc
    v_add_f32_dpp v15, v13, v13 row_half_mirror row_mask:0xf bank_mask:0x5
    s_nop 1
    v_add_f32_dpp v15, v17, v17 row_half_mirror row_mask:0xf bank_mask:0xa
    s_nop 1
    v_add_f32_dpp v15, v15, v15 quad_perm:[1,0,3,2] row_mask:0xf bank_mask:0xf
    s_nop 1
    v_add_f32_dpp v15, v15, v15 quad_perm:[2,3,0,1] row_mask:0xf bank_mask:0xf
    ds_write_b32 v4, v15 offset:224
    s_waitcnt vmcnt(6)
    s_cbranch_vccnz L_dy60
    s_waitcnt vmcnt(4)
L_dy60:
    buffer_load_dwordx4 v[172:175], v2, s[40:43], s56 offen nt
    s_add_u32 s56, s56, 0xd000
    s_and_b32 s56, s56, s63
    v_dot2_f32_bf16 v12, v96, v8, 0
    v_dot2_f32_bf16 v12, v97, v9, v12
    v_dot2_f32_bf16 v12, v98, v10, v12
    v_dot2_f32_bf16 v12, v99, v11, v12
    v_dot2_f32_bf16 v13, v100, v8, 0
    v_dot2_f32_bf16 v13, v101, v9, v13
    v_dot2_f32_bf16 v13, v102, v10, v13
    v_dot2_f32_bf16 v13, v103, v11, v13
    s_nop 2
    v_permlane16_swap_b32 v12, v13
    v_add_f32 v12, v12, v13
    s_waitcnt vmcnt(6)
    s_cbranch_vccnz L_dy61
    s_waitcnt vmcnt(4)
L_dy61:
    buffer_load_dwordx4 v[176:179], v2, s[40:43], s56 offen nt
    s_addk_i32 s56, 4096
    v_dot2_f32_bf16 v14, v104, v8, 0
    v_dot2_f32_bf16 v14, v105, v9, v14
    v_dot2_f32_bf16 v14, v106, v10, v14
    v_dot2_f32_bf16 v14, v107, v11, v14
    v_dot2_f32_bf16 v15, v108, v8, 0
    v_dot2_f32_bf16 v15, v109, v9, v15
    v_dot2_f32_bf16 v15, v110, v10, v15
    v_dot2_f32_bf16 v15, v111, v11, v15
    s_nop 2
    v_permlane16_swap_b32 v14, v15
    v_add_f32 v14, v14, v15
    v_add_f32_dpp v13, v12, v12 row_ror:8 row_mask:0xf bank_mask:0x3
    s_nop 1
    v_add_f32_dpp v13, v14, v14 row_ror:8 row_mask:0xf bank_mask:0xc
    s_waitcnt vmcnt(6)
    s_cbranch_vccnz L_dy62
    s_waitcnt vmcnt(4)
L_dy62:
    buffer_load_dwordx4 v[180:183], v2, s[40:43], s56 offen nt
    s_addk_i32 s56, 4096
    v_dot2_f32_bf16 v16, v112, v8, 0
    v_dot2_f32_bf16 v16, v113, v9, v16
    v_dot2_f32_bf16 v16, v114, v10, v16
    v_dot2_f32_bf16 v16, v115, v11, v16
    v_dot2_f32_bf16 v17, v116, v8, 0
    v_dot2_f32_bf16 v17, v117, v9, v17
    v_dot2_f32_bf16 v17, v118, v10, v17
    v_dot2_f32_bf16 v17, v119, v11, v17
    s_nop 2
    v_permlane16_swap_b32 v16, v17
    v_add_f32 v16, v16, v17
    s_waitcnt vmcnt(6)
    s_cbranch_vccnz L_dy63
    s_waitcnt vmcnt(4)
L_dy63:
    buffer_load_dwordx4 v[184:187], v2, s[40:43], s56 offen nt
    s_addk_i32 s56, 4096
    v_dot2_f32_bf16 v18, v120, v8, 0
    v_dot2_f32_bf16 v18, v121, v9, v18
    v_dot2_f32_bf16 v18, v122, v10, v18
    v_dot2_f32_bf16 v18, v123, v11, v18
    v_dot2_f32_bf16 v19, v124, v8, 0
    v_dot2_f32_bf16 v19, v125, v9, v19
    v_dot2_f32_bf16 v19, v126, v10, v19
    v_dot2_f32_bf16 v19, v127, v11, v19
    s_nop 2
    v_permlane16_swap_b32 v18, v19
    v_add_f32 v18, v18, v19
    v_add_f32_dpp v17, v16, v16 row_ror:8 row_mask:0xf bank_mask:0x3
    s_nop 1
    v_add_f32_dpp v17, v18, v18 row_ror:8 row_mask:0xf bank_mask:0xc
    v_add_f32_dpp v15, v13, v13 row_half_mirror row_mask:0xf bank_mask:0x5
    s_nop 1
    v_add_f32_dpp v15, v17, v17 row_half_mirror row_mask:0xf bank_mask:0xa
    s_nop 1
    v_add_f32_dpp v15, v15, v15 quad_perm:[1,0,3,2] row_mask:0xf bank_mask:0xf
    s_nop 1
    v_add_f32_dpp v15, v15, v15 quad_perm:[2,3,0,1] row_mask:0xf bank_mask:0xf
    ds_write_b32 v4, v15 offset:256
    s_waitcnt vmcnt(6)
    s_cbranch_vccnz L_dy64
    s_waitcnt vmcnt(4)
L_dy64:
    buffer_load_dwordx4 v[188:191], v2, s[40:43], s56 offen nt
    s_add_u32 s56, s56, 0xd000
    s_and_b32 s56, s56, s63
    v_dot2_f32_bf16 v12, v128, v8, 0
    v_dot2_f32_bf16 v12, v129, v9, v12
    v_dot2_f32_bf16 v12, v130, v10, v12
    v_dot2_f32_bf16 v12, v131, v11, v12
    v_dot2_f32_bf16 v13, v132, v8, 0
    v_dot2_f32_bf16 v13, v133, v9, v13
    v_dot2_f32_bf16 v13, v134, v10, v13
    v_dot2_f32_bf16 v13, v135, v11, v13
    s_nop 2
    v_permlane16_swap_b32 v12, v13
    v_add_f32 v12, v12, v13
    s_waitcnt vmcnt(6)
    s_cbranch_vccnz L_dy65
    s_cmp_eq_u32 s78, 0
    s_cbranch_scc1 L_dy65n
    s_waitcnt vmcnt(3)
L_dy65n:
    s_waitcnt vmcnt(4)
L_dy65:
    buffer_load_dwordx4 v[192:195], v2, s[40:43], s56 offen nt
    s_addk_i32 s56, 4096
    s_memrealtime s[76:77]
    v_dot2_f32_bf16 v14, v136, v8, 0
    v_dot2_f32_bf16 v14, v137, v9, v14
    v_dot2_f32_bf16 v14, v138, v10, v14
    v_dot2_f32_bf16 v14, v139, v11, v14
    v_dot2_f32_bf16 v15, v140, v8, 0
    v_dot2_f32_bf16 v15, v141, v9, v15
    v_dot2_f32_bf16 v15, v142, v10, v15
    v_dot2_f32_bf16 v15, v143, v11, v15
    s_nop 2
    v_permlane16_swap_b32 v14, v15
    v_add_f32 v14, v14, v15
    v_add_f32_dpp v13, v12, v12 row_ror:8 row_mask:0xf bank_mask:0x3
    s_nop 1
    v_add_f32_dpp v13, v14, v14 row_ror:8 row_mask:0xf bank_mask:0xc
    s_waitcnt vmcnt(6)
    s_cbranch_vccnz L_dy66
    s_cmp_eq_u32 s78, 0
    s_cbranch_scc1 L_dy66n
    s_waitcnt vmcnt(3)
L_dy66n:
    s_waitcnt vmcnt(4)
L_dy66:
    buffer_load_dwordx4 v[196:199], v2, s[40:43], s56 offen nt
    s_addk_i32 s56, 4096
    s_waitcnt lgkmcnt(0)
    s_mov_b32 s75, 0
    s_sub_u32 s8, s20, s76
    s_cmp_eq_u32 s20, 0
    s_cselect_b32 s8, 0, s8
    s_add_u32 s75, s75, s8
    s_sub_u32 s8, s21, s76
    s_cmp_eq_u32 s21, 0
    s_cselect_b32 s8, 0, s8
    s_add_u32 s75, s75, s8
    s_sub_u32 s8, s22, s76
    s_cmp_eq_u32 s22, 0
    s_cselect_b32 s8, 0, s8
    s_add_u32 s75, s75, s8
    s_sub_u32 s8, s23, s76
    s_cmp_eq_u32 s23, 0
    s_cselect_b32 s8, 0, s8
    s_add_u32 s75, s75, s8
    s_sub_u32 s8, s24, s76
    s_cmp_eq_u32 s24, 0
    s_cselect_b32 s8, 0, s8
    s_add_u32 s75, s75, s8
    s_sub_u32 s8, s25, s76
    s_cmp_eq_u32 s25, 0
    s_cselect_b32 s8, 0, s8
    s_add_u32 s75, s75, s8
    s_sub_u32 s8, s26, s76
    s_cmp_eq_u32 s26, 0
    s_cselect_b32 s8, 0, s8
    s_add_u32 s75, s75, s8
    s_sub_u32 s8, s27, s76
    s_cmp_eq_u32 s27, 0
    s_cselect_b32 s8, 0, s8
    s_add_u32 s75, s75, s8
    s_lshl_b32 s74, s76, 4
    s_lshl_b32 s75, s75, 1
    s_add_u32 s74, s74, s75
    s_sub_u32 s68, s74, s69
    s_mul_i32 s68, s68, 1014
    s_lshr_b32 s68, s68, 16
    s_max_u32 s68, s68, 216
    s_min_u32 s68, s68, 288
    s_mov_b32 s69, s74
    s_mul_i32 s8, s68, 24
    s_add_u32 s74, s74, s8
    s_mul_i32 s68, s68, 4
    s_lshl_b32 s9, s76, 4
    s_sub_u32 s8, s9, s74
    s_cmp_gt_i32 s8, s66
    s_cselect_b64 vcc, -1, 0
    s_cmpk_lt_i32 s8, -480
    s_cselect_b32 s78, 1, 0
    s_add_u32 s74, s74, s68
    v_dot2_f32_bf16 v16, v144, v8, 0
    v_dot2_f32_bf16 v16, v145, v9, v16
    v_dot2_f32_bf16 v16, v146, v10, v16
    v_dot2_f32_bf16 v16, v147, v11, v16
    v_dot2_f32_bf16 v17, v148, v8, 0
    v_dot2_f32_bf16 v17, v149, v9, v17
    v_dot2_f32_bf16 v17, v150, v10, v17
    v_dot2_f32_bf16 v17, v151, v11, v17
    s_nop 2
    v_permlane16_swap_b32 v16, v17
    v_add_f32 v16, v16, v17
    s_waitcnt vmcnt(6)
    s_cbranch_vccnz L_dy67
    s_cmp_eq_u32 s78, 0
    s_cbranch_scc1 L_dy67n
    s_waitcnt vmcnt(3)
L_dy67n:
    s_waitcnt vmcnt(4)
L_dy67:
    buffer_load_dwordx4 v[200:203], v2, s[40:43], s56 offen nt
    s_addk_i32 s56, 4096
    v_dot2_f32_bf16 v18, v152, v8, 0
    v_dot2_f32_bf16 v18, v153, v9, v18
    v_dot2_f32_bf16 v18, v154, v10, v18
    v_dot2_f32_bf16 v18, v155, v11, v18
    v_dot2_f32_bf16 v19, v156, v8, 0
    v_dot2_f32_bf16 v19, v157, v9, v19
    v_dot2_f32_bf16 v19, v158, v10, v19
    v_dot2_f32_bf16 v19, v159, v11, v19
    s_nop 2
    v_permlane16_swap_b32 v18, v19
    v_add_f32 v18, v18, v19
    v_add_f32_dpp v17, v16, v16 row_ror:8 row_mask:0xf bank_mask:0x3
    s_nop 1
    v_add_f32_dpp v17, v18, v18 row_ror:8 row_mask:0xf bank_mask:0xc
    v_add_f32_dpp v15, v13, v13 row_half_mirror row_mask:0xf bank_mask:0x5
    s_nop 1
    v_add_f32_dpp v15, v17, v17 row_half_mirror row_mask:0xf bank_mask:0xa
    s_nop 1
    v_add_f32_dpp v15, v15, v15 quad_perm:[1,0,3,2] row_mask:0xf bank_mask:0xf
    s_nop 1
    v_add_f32_dpp v15, v15, v15 quad_perm:[2,3,0,1] row_mask:0xf bank_mask:0xf
    ds_write_b32 v4, v15 offset:288
    s_waitcnt vmcnt(6)
    s_cbranch_vccnz L_dy68
    s_cmp_eq_u32 s78, 0
    s_cbranch_scc1 L_dy68n
    s_waitcnt vmcnt(3)
L_dy68n:
    s_waitcnt vmcnt(4)
L_dy68:
    buffer_load_dwordx4 v[204:207], v2, s[40:43], s56 offen nt
    s_add_u32 s56, s56, 0xd000
    s_and_b32 s56, s56, s63
    v_dot2_f32_bf16 v12, v160, v8, 0
    v_dot2_f32_bf16 v12, v161, v9, v12
    v_dot2_f32_bf16 v12, v162, v10, v12
    v_dot2_f32_bf16 v12, v163, v11, v12
    v_dot2_f32_bf16 v13, v164, v8, 0
    v_dot2_f32_bf16 v13, v165, v9, v13
    v_dot2_f32_bf16 v13, v166, v10, v13
    v_dot2_f32_bf16 v13, v167, v11, v13
    s_nop 2
    v_permlane16_swap_b32 v12, v13
    v_add_f32 v12, v12, v13
    s_waitcnt vmcnt(6)
    s_cbranch_vccnz L_dy69
    s_cmp_eq_u32 s78, 0
    s_cbranch_scc1 L_dy69n
    s_waitcnt vmcnt(3)
L_dy69n:
    s_waitcnt vmcnt(4)
L_dy69:
    buffer_load_dwordx4 v[208:211], v2, s[40:43], s56 offen nt
    s_addk_i32 s56, 4096
    s_memrealtime s[76:77]
    v_dot2_f32_bf16 v14, v168, v8, 0
    v_dot2_f32_bf16 v14, v169, v9, v14
    v_dot2_f32_bf16 v14, v170, v10, v14
    v_dot2_f32_bf16 v14, v171, v11, v14
    v_dot2_f32_bf16 v15, v172, v8, 0
    v_dot2_f32_bf16 v15, v173, v9, v15
    v_dot2_f32_bf16 v15, v174, v10, v15
    v_dot2_f32_bf16 v15, v175, v11, v15
    s_nop 2
    v_permlane16_swap_b32 v14, v15
    v_add_f32 v14, v14, v15
    v_add_f32_dpp v13, v12, v12 row_ror:8 row_mask:0xf bank_mask:0x3
    s_nop 1
    v_add_f32_dpp v13, v14, v14 row_ror:8 row_mask:0xf bank_mask:0xc
    s_waitcnt vmcnt(6)
    s_cbranch_vccnz L_dy70
    s_cmp_eq_u32 s78, 0
    s_cbranch_scc1 L_dy70n
    s_waitcnt vmcnt(3)
L_dy70n:
    s_waitcnt vmcnt(4)
L_dy70:
    buffer_load_dwordx4 v[212:215], v2, s[40:43], s56 offen nt
    s_addk_i32 s56, 4096
    s_waitcnt lgkmcnt(0)
    s_lshl_b32 s9, s76, 4
    s_sub_u32 s8, s9, s74
    s_cmp_gt_i32 s8, s66
    s_cselect_b64 vcc, -1, 0
    s_cmpk_lt_i32 s8, -480
    s_cselect_b32 s78, 1, 0
    s_add_u32 s74, s74, s68
    v_dot2_f32_bf16 v16, v176, v8, 0
    v_dot2_f32_bf16 v16, v177, v9, v16
    v_dot2_f32_bf16 v16, v178, v10, v16
    v_dot2_f32_bf16 v16, v179, v11, v16
    v_dot2_f32_bf16 v17, v180, v8, 0
    v_dot2_f32_bf16 v17, v181, v9, v17
    v_dot2_f32_bf16 v17, v182, v10, v17
    v_dot2_f32_bf16 v17, v183, v11, v17
    s_nop 2
    v_permlane16_swap_b32 v16, v17
    v_add_f32 v16, v16, v17
    s_waitcnt vmcnt(6)
    s_cbranch_vccnz L_dy71
    s_cmp_eq_u32 s78, 0
    s_cbranch_scc1 L_dy71n
    s_waitcnt vmcnt(3)
L_dy71n:
    s_waitcnt vmcnt(4)
L_dy71:
    buffer_load_dwordx4 v[216:219], v2, s[40:43], s56 offen nt
    s_addk_i32 s56, 4096
    v_dot2_f32_bf16 v18, v184, v8, 0
    v_dot2_f32_bf16 v18, v185, v9, v18
    v_dot2_f32_bf16 v18, v186, v10, v18
    v_dot2_f32_bf16 v18, v187, v11, v18
    v_dot2_f32_bf16 v19, v188, v8, 0
    v_dot2_f32_bf16 v19, v189, v9, v19
    v_dot2_f32_bf16 v19, v190, v10, v19
    v_dot2_f32_bf16 v19, v191, v11, v19
    s_nop 2
    v_permlane16_swap_b32 v18, v19
    v_add_f32 v18, v18, v19
    v_add_f32_dpp v17, v16, v16 row_ror:8 row_mask:0xf bank_mask:0x3
    s_nop 1
    v_add_f32_dpp v17, v18, v18 row_ror:8 row_mask:0xf bank_mask:0xc
    v_add_f32_dpp v15, v13, v13 row_half_mirror row_mask:0xf bank_mask:0x5
    s_nop 1
    v_add_f32_dpp v15, v17, v17 row_half_mirror row_mask:0xf bank_mask:0xa
    s_nop 1
    v_add_f32_dpp v15, v15, v15 quad_perm:[1,0,3,2] row_mask:0xf bank_mask:0xf
    s_nop 1
    v_add_f32_dpp v15, v15, v15 quad_perm:[2,3,0,1] row_mask:0xf bank_mask:0xf
    ds_write_b32 v4, v15 offset:320
    s_waitcnt vmcnt(6)
    s_cbranch_vccnz L_dy72
    s_cmp_eq_u32 s78, 0
    s_cbranch_scc1 L_dy72n
    s_waitcnt vmcnt(3)
L_dy72n:
    s_waitcnt vmcnt(4)
L_dy72:
    buffer_load_dwordx4 v[220:223], v2, s[40:43], s56 offen nt
    s_add_u32 s56, s56, 0xd000
    s_and_b32 s56, s56, s63
    v_dot2_f32_bf16 v12, v192, v8, 0
    v_dot2_f32_bf16 v12, v193, v9, v12
    v_dot2_f32_bf16 v12, v194, v10, v12
    v_dot2_f32_bf16 v12, v195, v11, v12
    s_waitcnt vmcnt(6)
    s_cbranch_vccnz L_dy73
    s_cmp_eq_u32 s78, 0
    s_cbranch_scc1 L_dy73n
    s_waitcnt vmcnt(3)
L_dy73n:
    s_waitcnt vmcnt(4)
L_dy73:
    buffer_load_dwordx4 v[224:227], v2, s[40:43], s56 offen nt
    s_addk_i32 s56, 4096
    s_movk_i32 s66, 560
    s_cmp_eq_u32 s6, 3
    s_cselect_b32 s66, 160, s66
    s_memrealtime s[76:77]
    v_dot2_f32_bf16 v13, v196, v8, 0
    v_dot2_f32_bf16 v13, v197, v9, v13
    v_dot2_f32_bf16 v13, v198, v10, v13
    v_dot2_f32_bf16 v13, v199, v11, v13
    s_nop 2
    v_permlane16_swap_b32 v12, v13
    v_add_f32 v12, v12, v13
    s_waitcnt vmcnt(6)
    s_cbranch_vccnz L_dy74
    s_cmp_eq_u32 s78, 0
    s_cbranch_scc1 L_dy74n
    s_waitcnt vmcnt(3)
L_dy74n:
    s_waitcnt vmcnt(4)
L_dy74:
    buffer_load_dwordx4 v[228:231], v2, s[40:43], s56 offen nt
    s_addk_i32 s56, 4096
    s_waitcnt lgkmcnt(0)
    s_lshl_b32 s9, s76, 4
    s_sub_u32 s8, s9, s74
    s_cmp_gt_i32 s8, s66
    s_cselect_b64 vcc, -1, 0
    s_cmpk_lt_i32 s8, -480
    s_cselect_b32 s78, 1, 0
    s_add_u32 s74, s74, s68
    v_dot2_f32_bf16 v14, v200, v8, 0
    v_dot2_f32_bf16 v14, v201, v9, v14
    v_dot2_f32_bf16 v14, v202, v10, v14
    v_dot2_f32_bf16 v14, v203, v11, v14
    s_waitcnt vmcnt(6)
    s_cbranch_vccnz L_dy75
    s_cmp_eq_u32 s78, 0
    s_cbranch_scc1 L_dy75n
    s_waitcnt vmcnt(3)
L_dy75n:
    s_waitcnt vmcnt(4)
L_dy75:
    buffer_load_dwordx4 v[232:235], v2, s[40:43], s56 offen nt
    s_addk_i32 s56, 4096
    v_dot2_f32_bf16 v15, v204, v8, 0
    v_dot2_f32_bf16 v15, v205, v9, v15
    v_dot2_f32_bf16 v15, v206, v10, v15
    v_dot2_f32_bf16 v15, v207, v11, v15
    s_nop 2
    v_permlane16_swap_b32 v14, v15
    v_add_f32 v14, v14, v15
    v_add_f32_dpp v13, v12, v12 row_ror:8 row_mask:0xf bank_mask:0x3
    s_nop 1
    v_add_f32_dpp v13, v14, v14 row_ror:8 row_mask:0xf bank_mask:0xc
    s_waitcnt vmcnt(6)
    s_cbranch_vccnz L_dy76
    s_cmp_eq_u32 s78, 0
    s_cbranch_scc1 L_dy76n
    s_waitcnt vmcnt(3)
L_dy76n:
    s_waitcnt vmcnt(4)
L_dy76:
    buffer_load_dwordx4 v[236:239], v2, s[40:43], s56 offen nt
    s_add_u32 s56, s56, 0xd000
    s_and_b32 s56, s56, s63
    v_dot2_f32_bf16 v16, v208, v8, 0
    v_dot2_f32_bf16 v16, v209, v9, v16
    v_dot2_f32_bf16 v16, v210, v10, v16
    v_dot2_f32_bf16 v16, v211, v11, v16
    s_waitcnt vmcnt(6)
    s_cbranch_vccnz L_dy77
    s_cmp_eq_u32 s78, 0
    s_cbranch_scc1 L_dy77n
    s_waitcnt vmcnt(3)
L_dy77n:
    s_waitcnt vmcnt(4)
L_dy77:
    buffer_load_dwordx4 v[240:243], v2, s[40:43], s56 offen nt
    s_addk_i32 s56, 4096
    s_memrealtime s[76:77]
    v_dot2_f32_bf16 v17, v212, v8, 0
    v_dot2_f32_bf16 v17, v213, v9, v17
    v_dot2_f32_bf16 v17, v214, v10, v17
    v_dot2_f32_bf16 v17, v215, v11, v17
    s_nop 2
    v_permlane16_swap_b32 v16, v17
    v_add_f32 v16, v16, v17
    s_waitcnt vmcnt(6)
    s_cbranch_vccnz L_dy78
    s_cmp_eq_u32 s78, 0
    s_cbranch_scc1 L_dy78n
    s_waitcnt vmcnt(3)
L_dy78n:
    s_waitcnt vmcnt(4)
L_dy78:
    buffer_load_dwordx4 v[244:247], v2, s[40:43], s56 offen nt
    s_addk_i32 s56, 4096
    s_waitcnt lgkmcnt(0)
    s_lshl_b32 s9, s76, 4
    s_sub_u32 s8, s9, s74
    s_cmp_gt_i32 s8, s66
    s_cselect_b64 vcc, -1, 0
    s_cmpk_lt_i32 s8, -480
    s_cselect_b32 s78, 1, 0
    s_add_u32 s74, s74, s68
    v_dot2_f32_bf16 v18, v216, v8, 0
    v_dot2_f32_bf16 v18, v217, v9, v18
    v_dot2_f32_bf16 v18, v218, v10, v18
    v_dot2_f32_bf16 v18, v219, v11, v18
    s_waitcnt vmcnt(6)
    s_cbranch_vccnz L_dy79
    s_cmp_eq_u32 s78, 0
    s_cbranch_scc1 L_dy79n
    s_waitcnt vmcnt(3)
L_dy79n:
    s_waitcnt vmcnt(4)
L_dy79:
    buffer_load_dwordx4 v[248:251], v2, s[40:43], s56 offen nt
    s_addk_i32 s56, 4096
    v_dot2_f32_bf16 v19, v220, v8, 0
    v_dot2_f32_bf16 v19, v221, v9, v19
    v_dot2_f32_bf16 v19, v222, v10, v19
    v_dot2_f32_bf16 v19, v223, v11, v19
    s_nop 2
    v_permlane16_swap_b32 v18, v19
    v_add_f32 v18, v18, v19
    v_add_f32_dpp v17, v16, v16 row_ror:8 row_mask:0xf bank_mask:0x3
    s_nop 1
    v_add_f32_dpp v17, v18, v18 row_ror:8 row_mask:0xf bank_mask:0xc
    v_add_f32_dpp v15, v13, v13 row_half_mirror row_mask:0xf bank_mask:0x5
    s_nop 1
    v_add_f32_dpp v15, v17, v17 row_half_mirror row_mask:0xf bank_mask:0xa
    s_nop 1
    v_add_f32_dpp v15, v15, v15 quad_perm:[1,0,3,2] row_mask:0xf bank_mask:0xf
    s_nop 1
    v_add_f32_dpp v15, v15, v15 quad_perm:[2,3,0,1] row_mask:0xf bank_mask:0xf
    ds_write_b32 v4, v15 offset:352
    s_waitcnt vmcnt(6)
    s_cbranch_vccnz L_dy80
    s_cmp_eq_u32 s78, 0
    s_cbranch_scc1 L_dy80n
    s_waitcnt vmcnt(3)
L_dy80n:
    s_waitcnt vmcnt(4)
L_dy80:
    buffer_load_dwordx4 v[252:255], v2, s[40:43], s56 offen nt
    s_add_u32 s56, s56, 0xd000
    s_and_b32 s56, s56, s63
    v_dot2_f32_bf16 v12, v224, v8, 0
    v_dot2_f32_bf16 v12, v225, v9, v12
    v_dot2_f32_bf16 v12, v226, v10, v12
    v_dot2_f32_bf16 v12, v227, v11, v12
    s_waitcnt vmcnt(6)
    s_cbranch_vccnz L_dy81
    s_cmp_eq_u32 s78, 0
    s_cbranch_scc1 L_dy81n
    s_waitcnt vmcnt(3)
L_dy81n:
    s_waitcnt vmcnt(4)
L_dy81:
    buffer_load_dwordx4 v[48:51], v2, s[40:43], s56 offen nt
    s_addk_i32 s56, 4096
    s_memrealtime s[76:77]
    v_dot2_f32_bf16 v13, v228, v8, 0
    v_dot2_f32_bf16 v13, v229, v9, v13
    v_dot2_f32_bf16 v13, v230, v10, v13
    v_dot2_f32_bf16 v13, v231, v11, v13
    s_nop 2
    v_permlane16_swap_b32 v12, v13
    v_add_f32 v12, v12, v13
    s_waitcnt vmcnt(6)
    s_cbranch_vccnz L_dy82
    s_cmp_eq_u32 s78, 0
    s_cbranch_scc1 L_dy82n
    s_waitcnt vmcnt(3)
L_dy82n:
    s_waitcnt vmcnt(4)
L_dy82:
    buffer_load_dwordx4 v[52:55], v2, s[40:43], s56 offen nt
    s_addk_i32 s56, 4096
    s_waitcnt lgkmcnt(0)
    s_lshl_b32 s9, s76, 4
    s_sub_u32 s8, s9, s74
    s_cmp_gt_i32 s8, s66
    s_cselect_b64 vcc, -1, 0
    s_cmpk_lt_i32 s8, -480
    s_cselect_b32 s78, 1, 0
    s_add_u32 s74, s74, s68
    v_dot2_f32_bf16 v14, v232, v8, 0
    v_dot2_f32_bf16 v14, v233, v9, v14
    v_dot2_f32_bf16 v14, v234, v10, v14
    v_dot2_f32_bf16 v14, v235, v11, v14
    s_waitcnt vmcnt(6)
    s_cbranch_vccnz L_dy83
    s_cmp_eq_u32 s78, 0
    s_cbranch_scc1 L_dy83n
    s_waitcnt vmcnt(3)
L_dy83n:
    s_waitcnt vmcnt(4)
L_dy83:
    buffer_load_dwordx4 v[56:59], v2, s[40:43], s56 offen nt
    s_addk_i32 s56, 4096
    v_dot2_f32_bf16 v15, v236, v8, 0
    v_dot2_f32_bf16 v15, v237, v9, v15
    v_dot2_f32_bf16 v15, v238, v10, v15
    v_dot2_f32_bf16 v15, v239, v11, v15
    s_nop 2
    v_permlane16_swap_b32 v14, v15
    v_add_f32 v14, v14, v15
    v_add_f32_dpp v13, v12, v12 row_ror:8 row_mask:0xf bank_mask:0x3
    s_nop 1
    v_add_f32_dpp v13, v14, v14 row_ror:8 row_mask:0xf bank_mask:0xc
    s_waitcnt vmcnt(6)
    s_cbranch_vccnz L_dy84
    s_cmp_eq_u32 s78, 0
    s_cbranch_scc1 L_dy84n
    s_waitcnt vmcnt(3)
L_dy84n:
    s_waitcnt vmcnt(4)
L_dy84:
    buffer_load_dwordx4 v[60:63], v2, s[40:43], s56 offen nt
    s_add_u32 s56, s56, 0xd000
    s_and_b32 s56, s56, s63
    v_dot2_f32_bf16 v16, v240, v8, 0
    v_dot2_f32_bf16 v16, v241, v9, v16
    v_dot2_f32_bf16 v16, v242, v10, v16
    v_dot2_f32_bf16 v16, v243, v11, v16
    s_waitcnt vmcnt(6)
    s_cbranch_vccnz L_dy85
    s_cmp_eq_u32 s78, 0
    s_cbranch_scc1 L_dy85n
    s_waitcnt vmcnt(3)
L_dy85n:
    s_waitcnt vmcnt(4)
L_dy85:
    buffer_load_dwordx4 v[64:67], v2, s[40:43], s56 offen nt
    s_addk_i32 s56, 4096
    s_memrealtime s[76:77]
    v_dot2_f32_bf16 v17, v244, v8, 0
    v_dot2_f32_bf16 v17, v245, v9, v17
    v_dot2_f32_bf16 v17, v246, v10, v17
    v_dot2_f32_bf16 v17, v247, v11, v17
    s_nop 2
    v_permlane16_swap_b32 v16, v17
    v_add_f32 v16, v16, v17
    s_waitcnt vmcnt(6)
    s_cbranch_vccnz L_dy86
    s_cmp_eq_u32 s78, 0
    s_cbranch_scc1 L_dy86n
    s_waitcnt vmcnt(3)
L_dy86n:
    s_waitcnt vmcnt(4)
L_dy86:
    buffer_load_dwordx4 v[68:71], v2, s[40:43], s56 offen nt
    s_addk_i32 s56, 4096
    s_waitcnt lgkmcnt(0)
    s_lshl_b32 s9, s76, 4
    s_sub_u32 s8, s9, s74
    s_cmp_gt_i32 s8, s66
    s_cselect_b64 vcc, -1, 0
    s_cmpk_lt_i32 s8, -480
    s_cselect_b32 s78, 1, 0
    s_add_u32 s74, s74, s68
    v_dot2_f32_bf16 v18, v248, v8, 0
    v_dot2_f32_bf16 v18, v249, v9, v18
    v_dot2_f32_bf16 v18, v250, v10, v18
    v_dot2_f32_bf16 v18, v251, v11, v18
    s_waitcnt vmcnt(6)
    s_cbranch_vccnz L_dy87
    s_cmp_eq_u32 s78, 0
    s_cbranch_scc1 L_dy87n
    s_waitcnt vmcnt(3)
L_dy87n:
    s_waitcnt vmcnt(4)
L_dy87:
    buffer_load_dwordx4 v[72:75], v2, s[40:43], s56 offen nt
    s_addk_i32 s56, 4096
    v_dot2_f32_bf16 v19, v252, v8, 0
    v_dot2_f32_bf16 v19, v253, v9, v19
    v_dot2_f32_bf16 v19, v254, v10, v19
    v_dot2_f32_bf16 v19, v255, v11, v19
    s_nop 2
    v_permlane16_swap_b32 v18, v19
    v_add_f32 v18, v18, v19
    v_add_f32_dpp v17, v16, v16 row_ror:8 row_mask:0xf bank_mask:0x3
    s_nop 1
    v_add_f32_dpp v17, v18, v18 row_ror:8 row_mask:0xf bank_mask:0xc
    v_add_f32_dpp v15, v13, v13 row_half_mirror row_mask:0xf bank_mask:0x5
    s_nop 1
    v_add_f32_dpp v15, v17, v17 row_half_mirror row_mask:0xf bank_mask:0xa
    s_nop 1
    v_add_f32_dpp v15, v15, v15 quad_perm:[1,0,3,2] row_mask:0xf bank_mask:0xf
    s_nop 1
    v_add_f32_dpp v15, v15, v15 quad_perm:[2,3,0,1] row_mask:0xf bank_mask:0xf
    ds_write_b32 v4, v15 offset:384
    s_waitcnt vmcnt(6)
    s_cbranch_vccnz L_dy88
    s_cmp_eq_u32 s78, 0
    s_cbranch_scc1 L_dy88n
    s_waitcnt vmcnt(3)
L_dy88n:
    s_waitcnt vmcnt(4)
L_dy88:
    buffer_load_dwordx4 v[76:79], v2, s[40:43], s56 offen nt
    s_add_u32 s56, s56, 0xd000
    s_and_b32 s56, s56, s63
    v_dot2_f32_bf16 v12, v48, v8, 0
    v_dot2_f32_bf16 v12, v49, v9, v12
    v_dot2_f32_bf16 v12, v50, v10, v12
    v_dot2_f32_bf16 v12, v51, v11, v12
    s_waitcnt vmcnt(6)
    s_cbranch_vccnz L_dy89
    s_cmp_eq_u32 s78, 0
    s_cbranch_scc1 L_dy89n
    s_waitcnt vmcnt(3)
L_dy89n:
    s_waitcnt vmcnt(4)
L_dy89:
    buffer_load_dwordx4 v[80:83], v2, s[40:43], s56 offen nt
    s_addk_i32 s56, 4096
    ds_max_u32 v22, v22 offset:12
    s_memrealtime s[76:77]
    v_dot2_f32_bf16 v13, v52, v8, 0
    v_dot2_f32_bf16 v13, v53, v9, v13
    v_dot2_f32_bf16 v13, v54, v10, v13
    v_dot2_f32_bf16 v13, v55, v11, v13
    s_nop 2
    v_permlane16_swap_b32 v12, v13
    v_add_f32 v12, v12, v13
    s_waitcnt vmcnt(6)
    s_cbranch_vccnz L_dy90
    s_cmp_eq_u32 s78, 0
    s_cbranch_scc1 L_dy90n
    s_waitcnt vmcnt(3)
L_dy90n:
    s_waitcnt vmcnt(4)
L_dy90:
    buffer_load_dwordx4 v[84:87], v2, s[40:43], s56 offen nt
    s_addk_i32 s56, 4096
    s_waitcnt lgkmcnt(0)
    s_lshl_b32 s9, s76, 4
    s_sub_u32 s8, s9, s74
    s_cmp_gt_i32 s8, s66
    s_cselect_b64 vcc, -1, 0
    s_cmpk_lt_i32 s8, -480
    s_cselect_b32 s78, 1, 0
    s_add_u32 s74, s74, s68
    v_dot2_f32_bf16 v14, v56, v8, 0
    v_dot2_f32_bf16 v14, v57, v9, v14
    v_dot2_f32_bf16 v14, v58, v10, v14
    v_dot2_f32_bf16 v14, v59, v11, v14
    s_waitcnt vmcnt(6)
    s_cbranch_vccnz L_dy91
    s_cmp_eq_u32 s78, 0
    s_cbranch_scc1 L_dy91n
    s_waitcnt vmcnt(3)
L_dy91n:
    s_waitcnt vmcnt(4)
L_dy91:
    buffer_load_dwordx4 v[88:91], v2, s[40:43], s56 offen nt
    s_addk_i32 s56, 4096
    v_dot2_f32_bf16 v15, v60, v8, 0
    v_dot2_f32_bf16 v15, v61, v9, v15
    v_dot2_f32_bf16 v15, v62, v10, v15
    v_dot2_f32_bf16 v15, v63, v11, v15
    s_nop 2
    v_permlane16_swap_b32 v14, v15
    v_add_f32 v14, v14, v15
    v_add_f32_dpp v13, v12, v12 row_ror:8 row_mask:0xf bank_mask:0x3
    s_nop 1
    v_add_f32_dpp v13, v14, v14 row_ror:8 row_mask:0xf bank_mask:0xc
    s_waitcnt vmcnt(6)
    s_cbranch_vccnz L_dy92
    s_cmp_eq_u32 s78, 0
    s_cbranch_scc1 L_dy92n
    s_waitcnt vmcnt(3)
L_dy92n:
    s_waitcnt vmcnt(4)
L_dy92:
    buffer_load_dwordx4 v[92:95], v2, s[40:43], s56 offen nt
    s_add_u32 s56, s56, 0xd000
    s_and_b32 s56, s56, s63
    v_dot2_f32_bf16 v16, v64, v8, 0
    v_dot2_f32_bf16 v16, v65, v9, v16
    v_dot2_f32_bf16 v16, v66, v10, v16
    v_dot2_f32_bf16 v16, v67, v11, v16
    s_waitcnt vmcnt(6)
    s_cbranch_vccnz L_dy93
    s_cmp_eq_u32 s78, 0
    s_cbranch_scc1 L_dy93n
    s_waitcnt vmcnt(3)
L_dy93n:
    s_waitcnt vmcnt(4)
L_dy93:
    buffer_load_dwordx4 v[96:99], v2, s[40:43], s56 offen nt
    s_addk_i32 s56, 4096
    s_memrealtime s[76:77]
    v_dot2_f32_bf16 v17, v68, v8, 0
    v_dot2_f32_bf16 v17, v69, v9, v17
    v_dot2_f32_bf16 v17, v70, v10, v17
    v_dot2_f32_bf16 v17, v71, v11, v17
    s_nop 2
    v_permlane16_swap_b32 v16, v17
    v_add_f32 v16, v16, v17
    s_waitcnt vmcnt(6)
    s_cbranch_vccnz L_dy94
    s_cmp_eq_u32 s78, 0
    s_cbranch_scc1 L_dy94n
    s_waitcnt vmcnt(3)
L_dy94n:
    s_waitcnt vmcnt(4)
L_dy94:
    buffer_load_dwordx4 v[100:103], v2, s[40:43], s56 offen nt
    s_addk_i32 s56, 4096
    s_waitcnt lgkmcnt(0)
    s_lshl_b32 s9, s76, 4
    s_sub_u32 s8, s9, s74
    s_cmp_gt_i32 s8, s66
    s_cselect_b64 vcc, -1, 0
    s_cmpk_lt_i32 s8, -480
    s_cselect_b32 s78, 1, 0
    s_add_u32 s74, s74, s68
    v_dot2_f32_bf16 v18, v72, v8, 0
    v_dot2_f32_bf16 v18, v73, v9, v18
    v_dot2_f32_bf16 v18, v74, v10, v18
    v_dot2_f32_bf16 v18, v75, v11, v18
    s_waitcnt vmcnt(6)
    s_cbranch_vccnz L_dy95
    s_cmp_eq_u32 s78, 0
    s_cbranch_scc1 L_dy95n
    s_waitcnt vmcnt(3)
L_dy95n:
    s_waitcnt vmcnt(4)
L_dy95:
    buffer_load_dwordx4 v[104:107], v2, s[40:43], s56 offen nt
    s_addk_i32 s56, 4096
    v_dot2_f32_bf16 v19, v76, v8, 0
    v_dot2_f32_bf16 v19, v77, v9, v19
    v_dot2_f32_bf16 v19, v78, v10, v19
    v_dot2_f32_bf16 v19, v79, v11, v19
    s_nop 2
    v_permlane16_swap_b32 v18, v19
    v_add_f32 v18, v18, v19
    v_add_f32_dpp v17, v16, v16 row_ror:8 row_mask:0xf bank_mask:0x3
    s_nop 1
    v_add_f32_dpp v17, v18, v18 row_ror:8 row_mask:0xf bank_mask:0xc
    v_add_f32_dpp v15, v13, v13 row_half_mirror row_mask:0xf bank_mask:0x5
    s_nop 1
    v_add_f32_dpp v15, v17, v17 row_half_mirror row_mask:0xf bank_mask:0xa
    s_nop 1
    v_add_f32_dpp v15, v15, v15 quad_perm:[1,0,3,2] row_mask:0xf bank_mask:0xf
    s_nop 1
    v_add_f32_dpp v15, v15, v15 quad_perm:[2,3,0,1] row_mask:0xf bank_mask:0xf
    ds_write_b32 v4, v15 offset:416
    s_waitcnt vmcnt(6)
    s_cbranch_vccnz L_dy96
    s_cmp_eq_u32 s78, 0
    s_cbranch_scc1 L_dy96n
    s_waitcnt vmcnt(3)
L_dy96n:
    s_waitcnt vmcnt(4)
L_dy96:
    buffer_load_dwordx4 v[108:111], v2, s[40:43], s56 offen nt
    s_add_u32 s56, s56, 0xd000
    s_and_b32 s56, s56, s63
    v_dot2_f32_bf16 v12, v80, v8, 0
    v_dot2_f32_bf16 v12, v81, v9, v12
    v_dot2_f32_bf16 v12, v82, v10, v12
    v_dot2_f32_bf16 v12, v83, v11, v12
    s_waitcnt vmcnt(6)
    s_cbranch_vccnz L_dy97
    s_cmp_eq_u32 s78, 0
    s_cbranch_scc1 L_dy97n
    s_waitcnt vmcnt(3)
L_dy97n:
    s_waitcnt vmcnt(4)
L_dy97:
    buffer_load_dwordx4 v[112:115], v2, s[40:43], s56 offen nt
    s_addk_i32 s56, 4096
    s_memrealtime s[76:77]
    v_dot2_f32_bf16 v13, v84, v8, 0
    v_dot2_f32_bf16 v13, v85, v9, v13
    v_dot2_f32_bf16 v13, v86, v10, v13
    v_dot2_f32_bf16 v13, v87, v11, v13
    s_nop 2
    v_permlane16_swap_b32 v12, v13
    v_add_f32 v12, v12, v13
    s_waitcnt vmcnt(6)
    s_cbranch_vccnz L_dy98
    s_cmp_eq_u32 s78, 0
    s_cbranch_scc1 L_dy98n
    s_waitcnt vmcnt(3)
L_dy98n:
    s_waitcnt vmcnt(4)
L_dy98:
    buffer_load_dwordx4 v[116:119], v2, s[40:43], s56 offen nt
    s_addk_i32 s56, 4096
    s_waitcnt lgkmcnt(0)
    s_lshl_b32 s9, s76, 4
    s_sub_u32 s8, s9, s74
    s_cmp_gt_i32 s8, s66
    s_cselect_b64 vcc, -1, 0
    s_cmpk_lt_i32 s8, -480
    s_cselect_b32 s78, 1, 0
    s_add_u32 s74, s74, s68
    v_dot2_f32_bf16 v14, v88, v8, 0
    v_dot2_f32_bf16 v14, v89, v9, v14
    v_dot2_f32_bf16 v14, v90, v10, v14
    v_dot2_f32_bf16 v14, v91, v11, v14
    s_waitcnt vmcnt(6)
    s_cbranch_vccnz L_dy99
    s_cmp_eq_u32 s78, 0
    s_cbranch_scc1 L_dy99n
    s_waitcnt vmcnt(3)
L_dy99n:
    s_waitcnt vmcnt(4)
L_dy99:
    buffer_load_dwordx4 v[120:123], v2, s[40:43], s56 offen nt
    s_addk_i32 s56, 4096
    v_dot2_f32_bf16 v15, v92, v8, 0
    v_dot2_f32_bf16 v15, v93, v9, v15
    v_dot2_f32_bf16 v15, v94, v10, v15
    v_dot2_f32_bf16 v15, v95, v11, v15
    s_nop 2
    v_permlane16_swap_b32 v14, v15
    v_add_f32 v14, v14, v15
    v_add_f32_dpp v13, v12, v12 row_ror:8 row_mask:0xf bank_mask:0x3
    s_nop 1
    v_add_f32_dpp v13, v14, v14 row_ror:8 row_mask:0xf bank_mask:0xc
    s_waitcnt vmcnt(6)
    s_cbranch_vccnz L_dy100
    s_cmp_eq_u32 s78, 0
    s_cbranch_scc1 L_dy100n
    s_waitcnt vmcnt(3)
L_dy100n:
    s_waitcnt vmcnt(4)
L_dy100:
    buffer_load_dwordx4 v[124:127], v2, s[40:43], s56 offen nt
    s_add_u32 s56, s56, 0xd000
    s_and_b32 s56, s56, s63
    v_dot2_f32_bf16 v16, v96, v8, 0
    v_dot2_f32_bf16 v16, v97, v9, v16
    v_dot2_f32_bf16 v16, v98, v10, v16
    v_dot2_f32_bf16 v16, v99, v11, v16
    s_waitcnt vmcnt(6)
    s_cbranch_vccnz L_dy101
    s_cmp_eq_u32 s78, 0
    s_cbranch_scc1 L_dy101n
    s_waitcnt vmcnt(3)
L_dy101n:
    s_waitcnt vmcnt(4)
L_dy101:
    buffer_load_dwordx4 v[128:131], v2, s[40:43], s56 offen nt
    s_addk_i32 s56, 4096
    s_memrealtime s[76:77]
    v_dot2_f32_bf16 v17, v100, v8, 0
    v_dot2_f32_bf16 v17, v101, v9, v17
    v_dot2_f32_bf16 v17, v102, v10, v17
    v_dot2_f32_bf16 v17, v103, v11, v17
    s_nop 2
    v_permlane16_swap_b32 v16, v17
    v_add_f32 v16, v16, v17
    s_waitcnt vmcnt(6)
    s_cbranch_vccnz L_dy102
    s_cmp_eq_u32 s78, 0
    s_cbranch_scc1 L_dy102n
    s_waitcnt vmcnt(3)
L_dy102n:
    s_waitcnt vmcnt(4)
L_dy102:
    buffer_load_dwordx4 v[132:135], v2, s[40:43], s56 offen nt
    s_addk_i32 s56, 4096
    s_waitcnt lgkmcnt(0)
    s_lshl_b32 s9, s76, 4
    s_sub_u32 s8, s9, s74
    s_cmp_gt_i32 s8, s66
    s_cselect_b64 vcc, -1, 0
    s_cmpk_lt_i32 s8, -480
    s_cselect_b32 s78, 1, 0
    s_add_u32 s74, s74, s68
    v_dot2_f32_bf16 v18, v104, v8, 0
    v_dot2_f32_bf16 v18, v105, v9, v18
    v_dot2_f32_bf16 v18, v106, v10, v18
    v_dot2_f32_bf16 v18, v107, v11, v18
    s_waitcnt vmcnt(6)
    s_cbranch_vccnz L_dy103
    s_cmp_eq_u32 s78, 0
    s_cbranch_scc1 L_dy103n
    s_waitcnt vmcnt(3)
L_dy103n:
    s_waitcnt vmcnt(4)
L_dy103:
    buffer_load_dwordx4 v[136:139], v2, s[40:43], s56 offen nt
    s_addk_i32 s56, 4096
    v_dot2_f32_bf16 v19, v108, v8, 0
    v_dot2_f32_bf16 v19, v109, v9, v19
    v_dot2_f32_bf16 v19, v110, v10, v19
    v_dot2_f32_bf16 v19, v111, v11, v19
    s_nop 2
    v_permlane16_swap_b32 v18, v19
    v_add_f32 v18, v18, v19
    v_add_f32_dpp v17, v16, v16 row_ror:8 row_mask:0xf bank_mask:0x3
    s_nop 1
    v_add_f32_dpp v17, v18, v18 row_ror:8 row_mask:0xf bank_mask:0xc
    v_add_f32_dpp v15, v13, v13 row_half_mirror row_mask:0xf bank_mask:0x5
    s_nop 1
    v_add_f32_dpp v15, v17, v17 row_half_mirror row_mask:0xf bank_mask:0xa
    s_nop 1
    v_add_f32_dpp v15, v15, v15 quad_perm:[1,0,3,2] row_mask:0xf bank_mask:0xf
    s_nop 1
    v_add_f32_dpp v15, v15, v15 quad_perm:[2,3,0,1] row_mask:0xf bank_mask:0xf
    ds_write_b32 v4, v15 offset:448
    s_waitcnt vmcnt(6)
    s_cbranch_vccnz L_dy104
    s_cmp_eq_u32 s78, 0
    s_cbranch_scc1 L_dy104n
    s_waitcnt vmcnt(3)
L_dy104n:
    s_waitcnt vmcnt(4)
L_dy104:
    buffer_load_dwordx4 v[140:143], v2, s[40:43], s56 offen nt
    v_dot2_f32_bf16 v12, v112, v8, 0
    v_dot2_f32_bf16 v12, v113, v9, v12
    v_dot2_f32_bf16 v12, v114, v10, v12
    v_dot2_f32_bf16 v12, v115, v11, v12
    s_waitcnt vmcnt(6)
    s_cbranch_vccnz L_dy105
    s_cmp_eq_u32 s78, 0
    s_cbranch_scc1 L_dy105n
    s_waitcnt vmcnt(3)
L_dy105n:
    s_waitcnt vmcnt(4)
L_dy105:
    buffer_load_dwordx4 v[144:147], v3, s[44:47], s57 offen nt
    s_addk_i32 s57, 4096
    s_movk_i32 s66, 1120
    s_cmp_eq_u32 s6, 3
    s_cselect_b32 s66, -320, s66
    s_memrealtime s[76:77]
    v_dot2_f32_bf16 v13, v116, v8, 0
    v_dot2_f32_bf16 v13, v117, v9, v13
    v_dot2_f32_bf16 v13, v118, v10, v13
    v_dot2_f32_bf16 v13, v119, v11, v13
    s_nop 2
    v_permlane16_swap_b32 v12, v13
    v_add_f32 v12, v12, v13
    s_waitcnt vmcnt(6)
    s_cbranch_vccnz L_dy106
    s_cmp_eq_u32 s78, 0
    s_cbranch_scc1 L_dy106n
    s_waitcnt vmcnt(3)
L_dy106n:
    s_waitcnt vmcnt(4)
L_dy106:
    buffer_load_dwordx4 v[148:151], v3, s[44:47], s57 offen nt
    s_addk_i32 s57, 4096
    s_waitcnt lgkmcnt(0)
    s_cmp_lg_u32 s58, 0
    s_cbranch_scc1 L_pb107
    s_or_b32 s8, s76, 1
    v_mov_b32 v47, s8
    s_mov_b64 exec, 1
    buffer_store_dword v47, off, s[52:55], s59 offset:64 sc1
    s_mov_b64 exec, -1
L_pb107:
    s_lshl_b32 s9, s76, 4
    s_sub_u32 s8, s9, s74
    s_cmp_gt_i32 s8, s66
    s_cselect_b64 vcc, -1, 0
    s_cmpk_lt_i32 s8, -480
    s_cselect_b32 s78, 1, 0
    s_add_u32 s74, s74, s68
    v_dot2_f32_bf16 v14, v120, v8, 0
    v_dot2_f32_bf16 v14, v121, v9, v14
    v_dot2_f32_bf16 v14, v122, v10, v14
    v_dot2_f32_bf16 v14, v123, v11, v14
    s_waitcnt vmcnt(6)
    s_cbranch_vccnz L_dy108
    s_cmp_eq_u32 s78, 0
    s_cbranch_scc1 L_dy108n
    s_waitcnt vmcnt(3)
L_dy108n:
    s_waitcnt vmcnt(4)
L_dy108:
    buffer_load_dwordx4 v[152:155], v3, s[44:47], s57 offen nt
    s_addk_i32 s57, 4096
    v_dot2_f32_bf16 v15, v124, v8, 0
    v_dot2_f32_bf16 v15, v125, v9, v15
    v_dot2_f32_bf16 v15, v126, v10, v15
    v_dot2_f32_bf16 v15, v127, v11, v15
    s_nop 2
    v_permlane16_swap_b32 v14, v15
    v_add_f32 v14, v14, v15
    v_add_f32_dpp v13, v12, v12 row_ror:8 row_mask:0xf bank_mask:0x3
    s_nop 1
    v_add_f32_dpp v13, v14, v14 row_ror:8 row_mask:0xf bank_mask:0xc
    s_waitcnt vmcnt(6)
    s_cbranch_vccnz L_dy109
    s_cmp_eq_u32 s78, 0
    s_cbranch_scc1 L_dy109n
    s_waitcnt vmcnt(3)
L_dy109n:
    s_waitcnt vmcnt(4)
L_dy109:
    buffer_load_dwordx4 v[156:159], v3, s[44:47], s57 offen nt
    s_add_u32 s57, s57, 0xd000
    s_and_b32 s57, s57, s63
    v_dot2_f32_bf16 v16, v128, v8, 0
    v_dot2_f32_bf16 v16, v129, v9, v16
    v_dot2_f32_bf16 v16, v130, v10, v16
    v_dot2_f32_bf16 v16, v131, v11, v16
    s_waitcnt vmcnt(6)
    s_cbranch_vccnz L_dy110
    s_cmp_eq_u32 s78, 0
    s_cbranch_scc1 L_dy110n
    s_waitcnt vmcnt(3)
L_dy110n:
    s_waitcnt vmcnt(4)
L_dy110:
    buffer_load_dwordx4 v[160:163], v3, s[44:47], s57 offen nt
    s_addk_i32 s57, 4096
    s_memrealtime s[76:77]
    v_dot2_f32_bf16 v17, v132, v8, 0
    v_dot2_f32_bf16 v17, v133, v9, v17
    v_dot2_f32_bf16 v17, v134, v10, v17
    v_dot2_f32_bf16 v17, v135, v11, v17
    s_nop 2
    v_permlane16_swap_b32 v16, v17
    v_add_f32 v16, v16, v17
    s_waitcnt vmcnt(6)
    s_cbranch_vccnz L_dy111
    s_cmp_eq_u32 s78, 0
    s_cbranch_scc1 L_dy111n
    s_waitcnt vmcnt(3)
L_dy111n:
    s_waitcnt vmcnt(4)
L_dy111:
    buffer_load_dwordx4 v[164:167], v3, s[44:47], s57 offen nt
    s_addk_i32 s57, 4096
    s_waitcnt lgkmcnt(0)
    s_lshl_b32 s9, s76, 4
    s_sub_u32 s8, s9, s74
    s_cmp_gt_i32 s8, s66
    s_cselect_b64 vcc, -1, 0
    s_cmpk_lt_i32 s8, -480
    s_cselect_b32 s78, 1, 0
    s_add_u32 s74, s74, s68
    v_dot2_f32_bf16 v18, v136, v8, 0
    v_dot2_f32_bf16 v18, v137, v9, v18
    v_dot2_f32_bf16 v18, v138, v10, v18
    v_dot2_f32_bf16 v18, v139, v11, v18
    s_waitcnt vmcnt(6)
    s_cbranch_vccnz L_dy112
    s_cmp_eq_u32 s78, 0
    s_cbranch_scc1 L_dy112n
    s_waitcnt vmcnt(3)
L_dy112n:
    s_waitcnt vmcnt(4)
L_dy112:
    buffer_load_dwordx4 v[168:171], v3, s[44:47], s57 offen nt
    s_addk_i32 s57, 4096
    v_dot2_f32_bf16 v19, v140, v8, 0
    v_dot2_f32_bf16 v19, v141, v9, v19
    v_dot2_f32_bf16 v19, v142, v10, v19
    v_dot2_f32_bf16 v19, v143, v11, v19
    s_nop 2
    v_permlane16_swap_b32 v18, v19
    v_add_f32 v18, v18, v19
    v_add_f32_dpp v17, v16, v16 row_ror:8 row_mask:0xf bank_mask:0x3
    s_nop 1
    v_add_f32_dpp v17, v18, v18 row_ror:8 row_mask:0xf bank_mask:0xc
    v_add_f32_dpp v15, v13, v13 row_half_mirror row_mask:0xf bank_mask:0x5
    s_nop 1
    v_add_f32_dpp v15, v17, v17 row_half_mirror row_mask:0xf bank_mask:0xa
    s_nop 1
    v_add_f32_dpp v15, v15, v15 quad_perm:[1,0,3,2] row_mask:0xf bank_mask:0xf
    s_nop 1
    v_add_f32_dpp v15, v15, v15 quad_perm:[2,3,0,1] row_mask:0xf bank_mask:0xf
    ds_write_b32 v4, v15 offset:480
    s_waitcnt lgkmcnt(0)
    ds_write_b32 v23, v44 offset:16
    s_waitcnt vmcnt(6)
    s_cbranch_vccnz L_dy113
    s_cmp_eq_u32 s78, 0
    s_cbranch_scc1 L_dy113n
    s_waitcnt vmcnt(3)
L_dy113n:
    s_waitcnt vmcnt(4)
L_dy113:
    buffer_load_dwordx4 v[172:175], v3, s[44:47], s57 offen nt
    s_add_u32 s57, s57, 0xd000
    s_and_b32 s57, s57, s63
    s_waitcnt vmcnt(6)
    s_cbranch_vccnz L_dy114
    s_cmp_eq_u32 s78, 0
    s_cbranch_scc1 L_dy114n
    s_waitcnt vmcnt(3)
L_dy114n:
    s_waitcnt vmcnt(4)
L_dy114:
    buffer_load_dwordx4 v[176:179], v3, s[44:47], s57 offen nt
    s_addk_i32 s57, 4096
    s_memrealtime s[76:77]
    s_waitcnt vmcnt(6)
    s_cbranch_vccnz L_dy115
    s_cmp_eq_u32 s78, 0
    s_cbranch_scc1 L_dy115n
    s_waitcnt vmcnt(3)
L_dy115n:
    s_waitcnt vmcnt(4)
L_dy115:
    buffer_load_dwordx4 v[180:183], v3, s[44:47], s57 offen nt
    s_addk_i32 s57, 4096
    s_waitcnt lgkmcnt(0)
    s_lshl_b32 s9, s76, 4
    s_sub_u32 s8, s9, s74
    s_cmp_gt_i32 s8, s66
    s_cselect_b64 vcc, -1, 0
    s_cmpk_lt_i32 s8, -480
    s_cselect_b32 s78, 1, 0
    s_add_u32 s74, s74, s68
    s_waitcnt vmcnt(6)
    s_cbranch_vccnz L_dy116
    s_cmp_eq_u32 s78, 0
    s_cbranch_scc1 L_dy116n
    s_waitcnt vmcnt(3)
L_dy116n:
    s_waitcnt vmcnt(4)
L_dy116:
    buffer_load_dwordx4 v[184:187], v3, s[44:47], s57 offen nt
    s_addk_i32 s57, 4096
    s_waitcnt vmcnt(6)
    s_cbranch_vccnz L_dy117
    s_cmp_eq_u32 s78, 0
    s_cbranch_scc1 L_dy117n
    s_waitcnt vmcnt(3)
L_dy117n:
    s_waitcnt vmcnt(4)
L_dy117:
    buffer_load_dwordx4 v[188:191], v3, s[44:47], s57 offen nt
    s_add_u32 s57, s57, 0xd000
    s_and_b32 s57, s57, s63
    s_waitcnt vmcnt(6)
    s_cbranch_vccnz L_dy118
    s_cmp_eq_u32 s78, 0
    s_cbranch_scc1 L_dy118n
    s_waitcnt vmcnt(3)
L_dy118n:
    s_waitcnt vmcnt(4)
L_dy118:
    buffer_load_dwordx4 v[192:195], v3, s[44:47], s57 offen nt
    s_addk_i32 s57, 4096
    s_memrealtime s[76:77]
    s_waitcnt vmcnt(6)
    s_cbranch_vccnz L_dy119
    s_cmp_eq_u32 s78, 0
    s_cbranch_scc1 L_dy119n
    s_waitcnt vmcnt(3)
L_dy119n:
    s_waitcnt vmcnt(4)
L_dy119:
    buffer_load_dwordx4 v[196:199], v3, s[44:47], s57 offen nt
    s_addk_i32 s57, 4096
    s_waitcnt lgkmcnt(0)
    s_lshl_b32 s9, s76, 4
    s_sub_u32 s8, s9, s74
    s_cmp_gt_i32 s8, s66
    s_cselect_b64 vcc, -1, 0
    s_cmpk_lt_i32 s8, -480
    s_cselect_b32 s78, 1, 0
    s_add_u32 s74, s74, s68
    s_waitcnt vmcnt(6)
    s_cbranch_vccnz L_dy120
    s_cmp_eq_u32 s78, 0
    s_cbranch_scc1 L_dy120n
    s_waitcnt vmcnt(3)
L_dy120n:
    s_waitcnt vmcnt(4)
L_dy120:
    buffer_load_dwordx4 v[200:203], v3, s[44:47], s57 offen nt
    s_addk_i32 s57, 4096
    s_waitcnt vmcnt(6)
    s_cbranch_vccnz L_dy121
    s_cmp_eq_u32 s78, 0
    s_cbranch_scc1 L_dy121n
    s_waitcnt vmcnt(3)
L_dy121n:
    s_waitcnt vmcnt(4)
L_dy121:
    buffer_load_dwordx4 v[204:207], v3, s[44:47], s57 offen nt
    s_add_u32 s57, s57, 0xd000
    s_and_b32 s57, s57, s63
    s_waitcnt vmcnt(6)
    s_cbranch_vccnz L_dy122
    s_cmp_eq_u32 s78, 0
    s_cbranch_scc1 L_dy122n
    s_waitcnt vmcnt(3)
L_dy122n:
    s_waitcnt vmcnt(4)
L_dy122:
    buffer_load_dwordx4 v[208:211], v3, s[44:47], s57 offen nt
    s_addk_i32 s57, 4096
    s_memrealtime s[76:77]
    s_waitcnt vmcnt(6)
    s_cbranch_vccnz L_dy123
    s_cmp_eq_u32 s78, 0
    s_cbranch_scc1 L_dy123n
    s_waitcnt vmcnt(3)
L_dy123n:
    s_waitcnt vmcnt(4)
L_dy123:
    buffer_load_dwordx4 v[212:215], v3, s[44:47], s57 offen nt
    s_addk_i32 s57, 4096
    s_waitcnt lgkmcnt(0)
    s_lshl_b32 s9, s76, 4
    s_sub_u32 s8, s9, s74
    s_cmp_gt_i32 s8, s66
    s_cselect_b64 vcc, -1, 0
    s_cmpk_lt_i32 s8, -480
    s_cselect_b32 s78, 1, 0
    s_add_u32 s74, s74, s68
    s_waitcnt vmcnt(6)
    s_cbranch_vccnz L_dy124
    s_cmp_eq_u32 s78, 0
    s_cbranch_scc1 L_dy124n
    s_waitcnt vmcnt(3)
L_dy124n:
    s_waitcnt vmcnt(4)
L_dy124:
    buffer_load_dwordx4 v[216:219], v3, s[44:47], s57 offen nt
    s_addk_i32 s57, 4096
    s_load_dwordx8 s[20:27], s[36:37], 64
    s_waitcnt vmcnt(6)
    s_cbranch_vccnz L_dy125
    s_cmp_eq_u32 s78, 0
    s_cbranch_scc1 L_dy125n
    s_waitcnt vmcnt(3)
L_dy125n:
    s_waitcnt vmcnt(4)
L_dy125:
    buffer_load_dwordx4 v[220:223], v3, s[44:47], s57 offen nt
    s_add_u32 s57, s57, 0xd000
    s_and_b32 s57, s57, s63
    s_waitcnt vmcnt(6)
    s_cbranch_vccnz L_dy126
    s_cmp_eq_u32 s78, 0
    s_cbranch_scc1 L_dy126n
    s_waitcnt vmcnt(3)
L_dy126n:
    s_waitcnt vmcnt(4)
L_dy126:
    buffer_load_dwordx4 v[224:227], v3, s[44:47], s57 offen nt
    s_addk_i32 s57, 4096
    s_waitcnt vmcnt(6)
    s_cbranch_vccnz L_dy127
    s_cmp_eq_u32 s78, 0
    s_cbranch_scc1 L_dy127n
    s_waitcnt vmcnt(3)
L_dy127n:
    s_waitcnt vmcnt(4)
L_dy127:
    buffer_load_dwordx4 v[228:231], v3, s[44:47], s57 offen nt
    s_addk_i32 s57, 4096
    s_waitcnt vmcnt(6)
    s_cbranch_vccnz L_dy128
    s_cmp_eq_u32 s78, 0
    s_cbranch_scc1 L_dy128n
    s_waitcnt vmcnt(3)
L_dy128n:
    s_waitcnt vmcnt(4)
L_dy128:
    buffer_load_dwordx4 v[232:235], v3, s[44:47], s57 offen nt
    s_addk_i32 s57, 4096
    s_waitcnt vmcnt(6)
    s_cbranch_vccnz L_dy129
    s_cmp_eq_u32 s78, 0
    s_cbranch_scc1 L_dy129n
    s_waitcnt vmcnt(3)
L_dy129n:
    s_waitcnt vmcnt(4)
L_dy129:
    buffer_load_dwordx4 v[236:239], v3, s[44:47], s57 offen nt
    s_add_u32 s57, s57, 0xd000
    s_and_b32 s57, s57, s63
    s_waitcnt vmcnt(6)
    s_cbranch_vccnz L_dy130
    s_cmp_eq_u32 s78, 0
    s_cbranch_scc1 L_dy130n
    s_waitcnt vmcnt(3)
L_dy130n:
    s_waitcnt vmcnt(4)
L_dy130:
    buffer_load_dwordx4 v[240:243], v3, s[44:47], s57 offen nt
    s_addk_i32 s57, 4096
    ds_write_b32 v23, v45 offset:16
    s_memrealtime s[76:77]
    s_waitcnt vmcnt(6)
    s_cbranch_vccnz L_dy131
    s_cmp_eq_u32 s78, 0
    s_cbranch_scc1 L_dy131n
    s_waitcnt vmcnt(3)
L_dy131n:
    s_waitcnt vmcnt(4)
L_dy131:
    buffer_load_dwordx4 v[244:247], v3, s[44:47], s57 offen nt
    s_addk_i32 s57, 4096
    s_waitcnt lgkmcnt(0)
    s_mov_b32 s75, 0
    s_sub_u32 s8, s20, s76
    s_cmp_eq_u32 s20, 0
    s_cselect_b32 s8, 0, s8
    s_add_u32 s75, s75, s8
    s_sub_u32 s8, s21, s76
    s_cmp_eq_u32 s21, 0
    s_cselect_b32 s8, 0, s8
    s_add_u32 s75, s75, s8
    s_sub_u32 s8, s22, s76
    s_cmp_eq_u32 s22, 0
    s_cselect_b32 s8, 0, s8
    s_add_u32 s75, s75, s8
    s_sub_u32 s8, s23, s76
    s_cmp_eq_u32 s23, 0
    s_cselect_b32 s8, 0, s8
    s_add_u32 s75, s75, s8
    s_sub_u32 s8, s24, s76
    s_cmp_eq_u32 s24, 0
    s_cselect_b32 s8, 0, s8
    s_add_u32 s75, s75, s8
    s_sub_u32 s8, s25, s76
    s_cmp_eq_u32 s25, 0
    s_cselect_b32 s8, 0, s8
    s_add_u32 s75, s75, s8
    s_sub_u32 s8, s26, s76
    s_cmp_eq_u32 s26, 0
    s_cselect_b32 s8, 0, s8
    s_add_u32 s75, s75, s8
    s_sub_u32 s8, s27, s76
    s_cmp_eq_u32 s27, 0
    s_cselect_b32 s8, 0, s8
    s_add_u32 s75, s75, s8
    s_lshl_b32 s74, s76, 4
    s_lshl_b32 s75, s75, 1
    s_add_u32 s74, s74, s75
    s_sub_u32 s68, s74, s69
    s_mul_i32 s68, s68, 1065
    s_lshr_b32 s68, s68, 16
    s_max_u32 s68, s68, 219
    s_min_u32 s68, s68, 288
    s_mov_b32 s69, s74
    s_mul_i32 s8, s68, 24
    s_add_u32 s74, s74, s8
    s_mul_i32 s68, s68, 4
    s_lshl_b32 s9, s76, 4
    s_sub_u32 s8, s9, s74
    s_cmp_gt_i32 s8, s66
    s_cselect_b64 vcc, -1, 0
    s_cmpk_lt_i32 s8, -480
    s_cselect_b32 s78, 1, 0
    s_add_u32 s74, s74, s68
    s_waitcnt vmcnt(6)
    s_cbranch_vccnz L_dy132
    s_cmp_eq_u32 s78, 0
    s_cbranch_scc1 L_dy132n
    s_waitcnt vmcnt(3)
L_dy132n:
    s_waitcnt vmcnt(4)
L_dy132:
    buffer_load_dwordx4 v[248:251], v3, s[44:47], s57 offen nt
    s_addk_i32 s57, 4096
    s_waitcnt vmcnt(6)
    s_cbranch_vccnz L_dy133
    s_cmp_eq_u32 s78, 0
    s_cbranch_scc1 L_dy133n
    s_waitcnt vmcnt(3)
L_dy133n:
    s_waitcnt vmcnt(4)
L_dy133:
    buffer_load_dwordx4 v[252:255], v3, s[44:47], s57 offen nt
    s_add_u32 s57, s57, 0xd000
    s_and_b32 s57, s57, s63
    s_waitcnt vmcnt(6)
    s_cbranch_vccnz L_dy134
    s_cmp_eq_u32 s78, 0
    s_cbranch_scc1 L_dy134n
    s_waitcnt vmcnt(3)
L_dy134n:
    s_waitcnt vmcnt(4)
L_dy134:
    buffer_load_dwordx4 v[48:51], v3, s[44:47], s57 offen nt
    s_addk_i32 s57, 4096
    s_memrealtime s[76:77]
    s_waitcnt vmcnt(6)
    s_cbranch_vccnz L_dy135
    s_cmp_eq_u32 s78, 0
    s_cbranch_scc1 L_dy135n
    s_waitcnt vmcnt(3)
L_dy135n:
    s_waitcnt vmcnt(4)
L_dy135:
    buffer_load_dwordx4 v[52:55], v3, s[44:47], s57 offen nt
    s_addk_i32 s57, 4096
    s_waitcnt lgkmcnt(0)
    s_lshl_b32 s9, s76, 4
    s_sub_u32 s8, s9, s74
    s_cmp_gt_i32 s8, s66
    s_cselect_b64 vcc, -1, 0
    s_cmpk_lt_i32 s8, -480
    s_cselect_b32 s78, 1, 0
    s_add_u32 s74, s74, s68
    s_waitcnt vmcnt(6)
    s_cbranch_vccnz L_dy136
    s_cmp_eq_u32 s78, 0
    s_cbranch_scc1 L_dy136n
    s_waitcnt vmcnt(3)
L_dy136n:
    s_waitcnt vmcnt(4)
L_dy136:
    buffer_load_dwordx4 v[56:59], v3, s[44:47], s57 offen nt
    s_addk_i32 s57, 4096
    s_waitcnt vmcnt(6)
    s_cbranch_vccnz L_dy137
    s_cmp_eq_u32 s78, 0
    s_cbranch_scc1 L_dy137n
    s_waitcnt vmcnt(3)
L_dy137n:
    s_waitcnt vmcnt(4)
L_dy137:
    buffer_load_dwordx4 v[60:63], v3, s[44:47], s57 offen nt
    s_add_u32 s57, s57, 0xd000
    s_and_b32 s57, s57, s63
    s_waitcnt vmcnt(6)
    s_cbranch_vccnz L_dy138
    s_cmp_eq_u32 s78, 0
    s_cbranch_scc1 L_dy138n
    s_waitcnt vmcnt(3)
L_dy138n:
    s_waitcnt vmcnt(4)
L_dy138:
    buffer_load_dwordx4 v[64:67], v3, s[44:47], s57 offen nt
    s_addk_i32 s57, 4096
    s_memrealtime s[76:77]
    s_waitcnt vmcnt(6)
    s_cbranch_vccnz L_dy139
    s_cmp_eq_u32 s78, 0
    s_cbranch_scc1 L_dy139n
    s_waitcnt vmcnt(3)
L_dy139n:
    s_waitcnt vmcnt(4)
L_dy139:
    buffer_load_dwordx4 v[68:71], v3, s[44:47], s57 offen nt
    s_addk_i32 s57, 4096
    s_waitcnt lgkmcnt(0)
    s_lshl_b32 s9, s76, 4
    s_sub_u32 s8, s9, s74
    s_cmp_gt_i32 s8, s66
    s_cselect_b64 vcc, -1, 0
    s_cmpk_lt_i32 s8, -480
    s_cselect_b32 s78, 1, 0
    s_add_u32 s74, s74, s68
    s_waitcnt vmcnt(6)
    s_cbranch_vccnz L_dy140
    s_cmp_eq_u32 s78, 0
    s_cbranch_scc1 L_dy140n
    s_waitcnt vmcnt(3)
L_dy140n:
    s_waitcnt vmcnt(4)
L_dy140:
    buffer_load_dwordx4 v[72:75], v3, s[44:47], s57 offen nt
    s_addk_i32 s57, 4096
    s_waitcnt vmcnt(6)
    s_cbranch_vccnz L_dy141
    s_cmp_eq_u32 s78, 0
    s_cbranch_scc1 L_dy141n
    s_waitcnt vmcnt(3)
L_dy141n:
    s_waitcnt vmcnt(4)
L_dy141:
    buffer_load_dwordx4 v[76:79], v3, s[44:47], s57 offen nt
    s_add_u32 s57, s57, 0xd000
    s_and_b32 s57, s57, s63
    s_waitcnt vmcnt(6)
    s_cbranch_vccnz L_dy142
    s_cmp_eq_u32 s78, 0
    s_cbranch_scc1 L_dy142n
    s_waitcnt vmcnt(3)
L_dy142n:
    s_waitcnt vmcnt(4)
L_dy142:
    buffer_load_dwordx4 v[80:83], v3, s[44:47], s57 offen nt
    s_addk_i32 s57, 4096
    s_memrealtime s[76:77]
    s_waitcnt vmcnt(6)
    s_cbranch_vccnz L_dy143
    s_cmp_eq_u32 s78, 0
    s_cbranch_scc1 L_dy143n
    s_waitcnt vmcnt(3)
L_dy143n:
    s_waitcnt vmcnt(4)
L_dy143:
    buffer_load_dwordx4 v[84:87], v3, s[44:47], s57 offen nt
    s_addk_i32 s57, 4096
    s_waitcnt lgkmcnt(0)
    s_lshl_b32 s9, s76, 4
    s_sub_u32 s8, s9, s74
    s_cmp_gt_i32 s8, s66
    s_cselect_b64 vcc, -1, 0
    s_cmpk_lt_i32 s8, -480
    s_cselect_b32 s78, 1, 0
    s_add_u32 s74, s74, s68
    s_waitcnt vmcnt(6)
    s_cbranch_vccnz L_dy144
    s_cmp_eq_u32 s78, 0
    s_cbranch_scc1 L_dy144n
    s_waitcnt vmcnt(3)
L_dy144n:
    s_waitcnt vmcnt(4)
L_dy144:
    buffer_load_dwordx4 v[88:91], v3, s[44:47], s57 offen nt
    s_addk_i32 s57, 4096
    s_waitcnt vmcnt(6)
    s_cbranch_vccnz L_dy145
    s_cmp_eq_u32 s78, 0
    s_cbranch_scc1 L_dy145n
    s_waitcnt vmcnt(3)
L_dy145n:
    s_waitcnt vmcnt(4)
L_dy145:
    buffer_load_dwordx4 v[92:95], v3, s[44:47], s57 offen nt
    s_add_u32 s57, s57, 0xd000
    s_and_b32 s57, s57, s63
    s_waitcnt vmcnt(6)
    s_cbranch_vccnz L_dy146
    s_cmp_eq_u32 s78, 0
    s_cbranch_scc1 L_dy146n
    s_waitcnt vmcnt(3)
L_dy146n:
    s_waitcnt vmcnt(4)
L_dy146:
    buffer_load_dwordx4 v[96:99], v3, s[44:47], s57 offen nt
    s_addk_i32 s57, 4096
    s_memrealtime s[76:77]
    s_waitcnt vmcnt(6)
    s_cbranch_vccnz L_dy147
    s_cmp_eq_u32 s78, 0
    s_cbranch_scc1 L_dy147n
    s_waitcnt vmcnt(3)
L_dy147n:
    s_waitcnt vmcnt(4)
L_dy147:
    buffer_load_dwordx4 v[100:103], v3, s[44:47], s57 offen nt
    s_addk_i32 s57, 4096
    s_waitcnt lgkmcnt(0)
    s_lshl_b32 s9, s76, 4
    s_sub_u32 s8, s9, s74
    s_cmp_gt_i32 s8, s66
    s_cselect_b64 vcc, -1, 0
    s_cmpk_lt_i32 s8, -480
    s_cselect_b32 s78, 1, 0
    s_add_u32 s74, s74, s68
    s_waitcnt vmcnt(6)
    s_cbranch_vccnz L_dy148
    s_cmp_eq_u32 s78, 0
    s_cbranch_scc1 L_dy148n
    s_waitcnt vmcnt(3)
L_dy148n:
    s_waitcnt vmcnt(4)
L_dy148:
    buffer_load_dwordx4 v[104:107], v3, s[44:47], s57 offen nt
    s_addk_i32 s57, 4096
    s_waitcnt vmcnt(6)
    s_cbranch_vccnz L_dy149
    s_cmp_eq_u32 s78, 0
    s_cbranch_scc1 L_dy149n
    s_waitcnt vmcnt(3)
L_dy149n:
    s_waitcnt vmcnt(4)
L_dy149:
    buffer_load_dwordx4 v[108:111], v3, s[44:47], s57 offen nt
    s_add_u32 s57, s57, 0xd000
    s_and_b32 s57, s57, s63
    s_waitcnt vmcnt(6)
    s_cbranch_vccnz L_dy150
    s_cmp_eq_u32 s78, 0
    s_cbranch_scc1 L_dy150n
    s_waitcnt vmcnt(3)
L_dy150n:
    s_waitcnt vmcnt(4)
L_dy150:
    buffer_load_dwordx4 v[112:115], v3, s[44:47], s57 offen nt
    s_addk_i32 s57, 4096
    s_memrealtime s[76:77]
    s_waitcnt vmcnt(6)
    s_cbranch_vccnz L_dy151
    s_cmp_eq_u32 s78, 0
    s_cbranch_scc1 L_dy151n
    s_waitcnt vmcnt(3)
L_dy151n:
    s_waitcnt vmcnt(4)
L_dy151:
    buffer_load_dwordx4 v[116:119], v3, s[44:47], s57 offen nt
    s_addk_i32 s57, 4096
    s_waitcnt lgkmcnt(0)
    s_lshl_b32 s9, s76, 4
    s_sub_u32 s8, s9, s74
    s_cmp_gt_i32 s8, s66
    s_cselect_b64 vcc, -1, 0
    s_cmpk_lt_i32 s8, -480
    s_cselect_b32 s78, 1, 0
    s_add_u32 s74, s74, s68
    s_waitcnt vmcnt(6)
    s_cbranch_vccnz L_dy152
    s_cmp_eq_u32 s78, 0
    s_cbranch_scc1 L_dy152n
    s_waitcnt vmcnt(3)
L_dy152n:
    s_waitcnt vmcnt(4)
L_dy152:
    buffer_load_dwordx4 v[120:123], v3, s[44:47], s57 offen nt
    s_addk_i32 s57, 4096
    s_waitcnt vmcnt(6)
    s_cbranch_vccnz L_dy153
    s_cmp_eq_u32 s78, 0
    s_cbranch_scc1 L_dy153n
    s_waitcnt vmcnt(3)
L_dy153n:
    s_waitcnt vmcnt(4)
L_dy153:
    buffer_load_dwordx4 v[124:127], v3, s[44:47], s57 offen nt
    s_add_u32 s57, s57, 0xd000
    s_and_b32 s57, s57, s63
    s_waitcnt vmcnt(6)
    s_cbranch_vccnz L_dy154
    s_cmp_eq_u32 s78, 0
    s_cbranch_scc1 L_dy154n
    s_waitcnt vmcnt(3)
L_dy154n:
    s_waitcnt vmcnt(4)
L_dy154:
    buffer_load_dwordx4 v[128:131], v3, s[44:47], s57 offen nt
    s_addk_i32 s57, 4096
    s_movk_i32 s66, 560
    s_cmp_eq_u32 s6, 3
    s_cselect_b32 s66, -320, s66
    s_memrealtime s[76:77]
    s_waitcnt vmcnt(6)
    s_cbranch_vccnz L_dy155
    s_cmp_eq_u32 s78, 0
    s_cbranch_scc1 L_dy155n
    s_waitcnt vmcnt(3)
L_dy155n:
    s_waitcnt vmcnt(4)
L_dy155:
    buffer_load_dwordx4 v[132:135], v3, s[44:47], s57 offen nt
    s_addk_i32 s57, 4096
    s_waitcnt lgkmcnt(0)
    s_lshl_b32 s9, s76, 4
    s_sub_u32 s8, s9, s74
    s_cmp_gt_i32 s8, s66
    s_cselect_b64 vcc, -1, 0
    s_cmpk_lt_i32 s8, -480
    s_cselect_b32 s78, 1, 0
    s_add_u32 s74, s74, s68
    ds_read_b32 v46, v23 offset:32
    ds_read_b128 v[32:35], v5
    s_waitcnt vmcnt(6)
    s_cbranch_vccnz L_dy156
    s_cmp_eq_u32 s78, 0
    s_cbranch_scc1 L_dy156n
    s_waitcnt vmcnt(3)
L_dy156n:
    s_waitcnt vmcnt(4)
L_dy156:
    buffer_load_dwordx4 v[136:139], v3, s[44:47], s57 offen nt
    s_addk_i32 s57, 4096
    s_waitcnt lgkmcnt(0)
    v_readfirstlane_b32 s8, v46
    s_nop 0
    s_cmp_eq_u32 s8, 0
    s_cbranch_scc1 L_pslow
L_pback:
    s_waitcnt vmcnt(6)
    s_cbranch_vccnz L_dy157
    s_cmp_eq_u32 s78, 0
    s_cbranch_scc1 L_dy157n
    s_waitcnt vmcnt(3)
L_dy157n:
    s_waitcnt vmcnt(4)
L_dy157:
    buffer_load_dwordx4 v[140:143], v3, s[44:47], s57 offen nt
    s_add_u32 s57, s57, 0xd000
    s_and_b32 s57, s57, s63
    s_waitcnt lgkmcnt(0)
    ds_read_b128 v[36:39], v5 offset:16
    v_perm_b32 v40, v148, v144, s60
    v_perm_b32 v41, v148, v144, s61
    v_dot2c_f32_bf16 v24, v40, v32
    v_dot2c_f32_bf16 v25, v41, v32
    v_perm_b32 v42, v149, v145, s60
    v_perm_b32 v43, v149, v145, s61
    v_dot2c_f32_bf16 v26, v42, v32
    v_dot2c_f32_bf16 v27, v43, v32
    v_perm_b32 v40, v150, v146, s60
    v_perm_b32 v41, v150, v146, s61
    v_dot2c_f32_bf16 v28, v40, v32
    v_dot2c_f32_bf16 v29, v41, v32
    v_perm_b32 v42, v151, v147, s60
    v_perm_b32 v43, v151, v147, s61
    v_dot2c_f32_bf16 v30, v42, v32
    v_dot2c_f32_bf16 v31, v43, v32
    v_perm_b32 v40, v156, v152, s60
    v_perm_b32 v41, v156, v152, s61
    v_dot2c_f32_bf16 v24, v40, v33
    v_dot2c_f32_bf16 v25, v41, v33
    v_perm_b32 v42, v157, v153, s60
    v_perm_b32 v43, v157, v153, s61
    v_dot2c_f32_bf16 v26, v42, v33
    v_dot2c_f32_bf16 v27, v43, v33
    v_perm_b32 v40, v158, v154, s60
    v_perm_b32 v41, v158, v154, s61
    v_dot2c_f32_bf16 v28, v40, v33
    v_dot2c_f32_bf16 v29, v41, v33
    v_perm_b32 v42, v159, v155, s60
    v_perm_b32 v43, v159, v155, s61
    v_dot2c_f32_bf16 v30, v42, v33
    v_dot2c_f32_bf16 v31, v43, v33
    s_waitcnt vmcnt(6)
    s_cbranch_vccnz L_dy158
    s_cmp_eq_u32 s78, 0
    s_cbranch_scc1 L_dy158n
    s_waitcnt vmcnt(3)
L_dy158n:
    s_waitcnt vmcnt(4)
L_dy158:
    buffer_load_dwordx4 v[144:147], v3, s[44:47], s57 offen nt
    s_addk_i32 s57, 4096
    s_memrealtime s[76:77]
    v_perm_b32 v40, v164, v160, s60
    v_perm_b32 v41, v164, v160, s61
    v_dot2c_f32_bf16 v24, v40, v34
    v_dot2c_f32_bf16 v25, v41, v34
    v_perm_b32 v42, v165, v161, s60
    v_perm_b32 v43, v165, v161, s61
    v_dot2c_f32_bf16 v26, v42, v34
    v_dot2c_f32_bf16 v27, v43, v34
    v_perm_b32 v40, v166, v162, s60
    v_perm_b32 v41, v166, v162, s61
    v_dot2c_f32_bf16 v28, v40, v34
    v_dot2c_f32_bf16 v29, v41, v34
    v_perm_b32 v42, v167, v163, s60
    v_perm_b32 v43, v167, v163, s61
    v_dot2c_f32_bf16 v30, v42, v34
    v_dot2c_f32_bf16 v31, v43, v34
    v_perm_b32 v40, v172, v168, s60
    v_perm_b32 v41, v172, v168, s61
    v_dot2c_f32_bf16 v24, v40, v35
    v_dot2c_f32_bf16 v25, v41, v35
    v_perm_b32 v42, v173, v169, s60
    v_perm_b32 v43, v173, v169, s61
    v_dot2c_f32_bf16 v26, v42, v35
    v_dot2c_f32_bf16 v27, v43, v35
    v_perm_b32 v40, v174, v170, s60
    v_perm_b32 v41, v174, v170, s61
    v_dot2c_f32_bf16 v28, v40, v35
    v_dot2c_f32_bf16 v29, v41, v35
    v_perm_b32 v42, v175, v171, s60
    v_perm_b32 v43, v175, v171, s61
    v_dot2c_f32_bf16 v30, v42, v35
    v_dot2c_f32_bf16 v31, v43, v35
    s_waitcnt vmcnt(6)
    s_cbranch_vccnz L_dy159
    s_cmp_eq_u32 s78, 0
    s_cbranch_scc1 L_dy159n
    s_waitcnt vmcnt(3)
L_dy159n:
    s_waitcnt vmcnt(4)
L_dy159:
    buffer_load_dwordx4 v[148:151], v3, s[44:47], s57 offen nt
    s_addk_i32 s57, 4096
    s_waitcnt lgkmcnt(0)
    s_lshl_b32 s9, s76, 4
    s_sub_u32 s8, s9, s74
    s_cmp_gt_i32 s8, s66
    s_cselect_b64 vcc, -1, 0
    s_cmpk_lt_i32 s8, -480
    s_cselect_b32 s78, 1, 0
    s_add_u32 s74, s74, s68
    s_waitcnt lgkmcnt(0)
    ds_read_b128 v[32:35], v5 offset:32
    v_perm_b32 v40, v180, v176, s60
    v_perm_b32 v41, v180, v176, s61
    v_dot2c_f32_bf16 v24, v40, v36
    v_dot2c_f32_bf16 v25, v41, v36
    v_perm_b32 v42, v181, v177, s60
    v_perm_b32 v43, v181, v177, s61
    v_dot2c_f32_bf16 v26, v42, v36
    v_dot2c_f32_bf16 v27, v43, v36
    v_perm_b32 v40, v182, v178, s60
    v_perm_b32 v41, v182, v178, s61
    v_dot2c_f32_bf16 v28, v40, v36
    v_dot2c_f32_bf16 v29, v41, v36
    v_perm_b32 v42, v183, v179, s60
    v_perm_b32 v43, v183, v179, s61
    v_dot2c_f32_bf16 v30, v42, v36
    v_dot2c_f32_bf16 v31, v43, v36
    v_perm_b32 v40, v188, v184, s60
    v_perm_b32 v41, v188, v184, s61
    v_dot2c_f32_bf16 v24, v40, v37
    v_dot2c_f32_bf16 v25, v41, v37
    v_perm_b32 v42, v189, v185, s60
    v_perm_b32 v43, v189, v185, s61
    v_dot2c_f32_bf16 v26, v42, v37
    v_dot2c_f32_bf16 v27, v43, v37
    v_perm_b32 v40, v190, v186, s60
    v_perm_b32 v41, v190, v186, s61
    v_dot2c_f32_bf16 v28, v40, v37
    v_dot2c_f32_bf16 v29, v41, v37
    v_perm_b32 v42, v191, v187, s60
    v_perm_b32 v43, v191, v187, s61
    v_dot2c_f32_bf16 v30, v42, v37
    v_dot2c_f32_bf16 v31, v43, v37
    s_waitcnt vmcnt(6)
    s_cbranch_vccnz L_dy160
    s_cmp_eq_u32 s78, 0
    s_cbranch_scc1 L_dy160n
    s_waitcnt vmcnt(3)
L_dy160n:
    s_waitcnt vmcnt(4)
L_dy160:
    buffer_load_dwordx4 v[152:155], v3, s[44:47], s57 offen nt
    s_addk_i32 s57, 4096
    v_perm_b32 v40, v196, v192, s60
    v_perm_b32 v41, v196, v192, s61
    v_dot2c_f32_bf16 v24, v40, v38
    v_dot2c_f32_bf16 v25, v41, v38
    v_perm_b32 v42, v197, v193, s60
    v_perm_b32 v43, v197, v193, s61
    v_dot2c_f32_bf16 v26, v42, v38
    v_dot2c_f32_bf16 v27, v43, v38
    v_perm_b32 v40, v198, v194, s60
    v_perm_b32 v41, v198, v194, s61
    v_dot2c_f32_bf16 v28, v40, v38
    v_dot2c_f32_bf16 v29, v41, v38
    v_perm_b32 v42, v199, v195, s60
    v_perm_b32 v43, v199, v195, s61
    v_dot2c_f32_bf16 v30, v42, v38
    v_dot2c_f32_bf16 v31, v43, v38
    v_perm_b32 v40, v204, v200, s60
    v_perm_b32 v41, v204, v200, s61
    v_dot2c_f32_bf16 v24, v40, v39
    v_dot2c_f32_bf16 v25, v41, v39
    v_perm_b32 v42, v205, v201, s60
    v_perm_b32 v43, v205, v201, s61
    v_dot2c_f32_bf16 v26, v42, v39
    v_dot2c_f32_bf16 v27, v43, v39
    v_perm_b32 v40, v206, v202, s60
    v_perm_b32 v41, v206, v202, s61
    v_dot2c_f32_bf16 v28, v40, v39
    v_dot2c_f32_bf16 v29, v41, v39
    v_perm_b32 v42, v207, v203, s60
    v_perm_b32 v43, v207, v203, s61
    v_dot2c_f32_bf16 v30, v42, v39
    v_dot2c_f32_bf16 v31, v43, v39
    s_waitcnt vmcnt(6)
    s_cbranch_vccnz L_dy161
    s_cmp_eq_u32 s78, 0
    s_cbranch_scc1 L_dy161n
    s_waitcnt vmcnt(3)
L_dy161n:
    s_waitcnt vmcnt(4)
L_dy161:
    buffer_load_dwordx4 v[156:159], v3, s[44:47], s57 offen nt
    s_add_u32 s57, s57, 0xd000
    s_and_b32 s57, s57, s63
    s_waitcnt lgkmcnt(0)
    ds_read_b128 v[36:39], v5 offset:48
    v_perm_b32 v40, v212, v208, s60
    v_perm_b32 v41, v212, v208, s61
    v_dot2c_f32_bf16 v24, v40, v32
    v_dot2c_f32_bf16 v25, v41, v32
    v_perm_b32 v42, v213, v209, s60
    v_perm_b32 v43, v213, v209, s61
    v_dot2c_f32_bf16 v26, v42, v32
    v_dot2c_f32_bf16 v27, v43, v32
    v_perm_b32 v40, v214, v210, s60
    v_perm_b32 v41, v214, v210, s61
    v_dot2c_f32_bf16 v28, v40, v32
    v_dot2c_f32_bf16 v29, v41, v32
    v_perm_b32 v42, v215, v211, s60
    v_perm_b32 v43, v215, v211, s61
    v_dot2c_f32_bf16 v30, v42, v32
    v_dot2c_f32_bf16 v31, v43, v32
    v_perm_b32 v40, v220, v216, s60
    v_perm_b32 v41, v220, v216, s61
    v_dot2c_f32_bf16 v24, v40, v33
    v_dot2c_f32_bf16 v25, v41, v33
    v_perm_b32 v42, v221, v217, s60
    v_perm_b32 v43, v221, v217, s61
    v_dot2c_f32_bf16 v26, v42, v33
    v_dot2c_f32_bf16 v27, v43, v33
    v_perm_b32 v40, v222, v218, s60
    v_perm_b32 v41, v222, v218, s61
    v_dot2c_f32_bf16 v28, v40, v33
    v_dot2c_f32_bf16 v29, v41, v33
    v_perm_b32 v42, v223, v219, s60
    v_perm_b32 v43, v223, v219, s61
    v_dot2c_f32_bf16 v30, v42, v33
    v_dot2c_f32_bf16 v31, v43, v33
    s_waitcnt vmcnt(6)
    s_cbranch_vccnz L_dy162
    s_cmp_eq_u32 s78, 0
    s_cbranch_scc1 L_dy162n
    s_waitcnt vmcnt(3)
L_dy162n:
    s_waitcnt vmcnt(4)
L_dy162:
    buffer_load_dwordx4 v[160:163], v3, s[44:47], s57 offen nt
    s_addk_i32 s57, 4096
    s_memrealtime s[76:77]
    v_perm_b32 v40, v228, v224, s60
    v_perm_b32 v41, v228, v224, s61
    v_dot2c_f32_bf16 v24, v40, v34
    v_dot2c_f32_bf16 v25, v41, v34
    v_perm_b32 v42, v229, v225, s60
    v_perm_b32 v43, v229, v225, s61
    v_dot2c_f32_bf16 v26, v42, v34
    v_dot2c_f32_bf16 v27, v43, v34
    v_perm_b32 v40, v230, v226, s60
    v_perm_b32 v41, v230, v226, s61
    v_dot2c_f32_bf16 v28, v40, v34
    v_dot2c_f32_bf16 v29, v41, v34
    v_perm_b32 v42, v231, v227, s60
    v_perm_b32 v43, v231, v227, s61
    v_dot2c_f32_bf16 v30, v42, v34
    v_dot2c_f32_bf16 v31, v43, v34
    v_perm_b32 v40, v236, v232, s60
    v_perm_b32 v41, v236, v232, s61
    v_dot2c_f32_bf16 v24, v40, v35
    v_dot2c_f32_bf16 v25, v41, v35
    v_perm_b32 v42, v237, v233, s60
    v_perm_b32 v43, v237, v233, s61
    v_dot2c_f32_bf16 v26, v42, v35
    v_dot2c_f32_bf16 v27, v43, v35
    v_perm_b32 v40, v238, v234, s60
    v_perm_b32 v41, v238, v234, s61
    v_dot2c_f32_bf16 v28, v40, v35
    v_dot2c_f32_bf16 v29, v41, v35
    v_perm_b32 v42, v239, v235, s60
    v_perm_b32 v43, v239, v235, s61
    v_dot2c_f32_bf16 v30, v42, v35
    v_dot2c_f32_bf16 v31, v43, v35
    s_waitcnt vmcnt(6)
    s_cbranch_vccnz L_dy163
    s_cmp_eq_u32 s78, 0
    s_cbranch_scc1 L_dy163n
    s_waitcnt vmcnt(3)
L_dy163n:
    s_waitcnt vmcnt(4)
L_dy163:
    buffer_load_dwordx4 v[164:167], v3, s[44:47], s57 offen nt
    s_addk_i32 s57, 4096
    s_waitcnt lgkmcnt(0)
    s_lshl_b32 s9, s76, 4
    s_sub_u32 s8, s9, s74
    s_cmp_gt_i32 s8, s66
    s_cselect_b64 vcc, -1, 0
    s_cmpk_lt_i32 s8, -480
    s_cselect_b32 s78, 1, 0
    s_add_u32 s74, s74, s68
    s_waitcnt lgkmcnt(0)
    ds_read_b128 v[32:35], v5 offset:64
    v_perm_b32 v40, v244, v240, s60
    v_perm_b32 v41, v244, v240, s61
    v_dot2c_f32_bf16 v24, v40, v36
    v_dot2c_f32_bf16 v25, v41, v36
    v_perm_b32 v42, v245, v241, s60
    v_perm_b32 v43, v245, v241, s61
    v_dot2c_f32_bf16 v26, v42, v36
    v_dot2c_f32_bf16 v27, v43, v36
    v_perm_b32 v40, v246, v242, s60
    v_perm_b32 v41, v246, v242, s61
    v_dot2c_f32_bf16 v28, v40, v36
    v_dot2c_f32_bf16 v29, v41, v36
    v_perm_b32 v42, v247, v243, s60
    v_perm_b32 v43, v247, v243, s61
    v_dot2c_f32_bf16 v30, v42, v36
    v_dot2c_f32_bf16 v31, v43, v36
    v_perm_b32 v40, v252, v248, s60
    v_perm_b32 v41, v252, v248, s61
    v_dot2c_f32_bf16 v24, v40, v37
    v_dot2c_f32_bf16 v25, v41, v37
    v_perm_b32 v42, v253, v249, s60
    v_perm_b32 v43, v253, v249, s61
    v_dot2c_f32_bf16 v26, v42, v37
    v_dot2c_f32_bf16 v27, v43, v37
    v_perm_b32 v40, v254, v250, s60
    v_perm_b32 v41, v254, v250, s61
    v_dot2c_f32_bf16 v28, v40, v37
    v_dot2c_f32_bf16 v29, v41, v37
    v_perm_b32 v42, v255, v251, s60
    v_perm_b32 v43, v255, v251, s61
    v_dot2c_f32_bf16 v30, v42, v37
    v_dot2c_f32_bf16 v31, v43, v37
    s_waitcnt vmcnt(6)
    s_cbranch_vccnz L_dy164
    s_cmp_eq_u32 s78, 0
    s_cbranch_scc1 L_dy164n
    s_waitcnt vmcnt(3)
L_dy164n:
    s_waitcnt vmcnt(4)
L_dy164:
    buffer_load_dwordx4 v[168:171], v3, s[44:47], s57 offen nt
    s_addk_i32 s57, 4096
    v_perm_b32 v40, v52, v48, s60
    v_perm_b32 v41, v52, v48, s61
    v_dot2c_f32_bf16 v24, v40, v38
    v_dot2c_f32_bf16 v25, v41, v38
    v_perm_b32 v42, v53, v49, s60
    v_perm_b32 v43, v53, v49, s61
    v_dot2c_f32_bf16 v26, v42, v38
    v_dot2c_f32_bf16 v27, v43, v38
    v_perm_b32 v40, v54, v50, s60
    v_perm_b32 v41, v54, v50, s61
    v_dot2c_f32_bf16 v28, v40, v38
    v_dot2c_f32_bf16 v29, v41, v38
    v_perm_b32 v42, v55, v51, s60
    v_perm_b32 v43, v55, v51, s61
    v_dot2c_f32_bf16 v30, v42, v38
    v_dot2c_f32_bf16 v31, v43, v38
    v_perm_b32 v40, v60, v56, s60
    v_perm_b32 v41, v60, v56, s61
    v_dot2c_f32_bf16 v24, v40, v39
    v_dot2c_f32_bf16 v25, v41, v39
    v_perm_b32 v42, v61, v57, s60
    v_perm_b32 v43, v61, v57, s61
    v_dot2c_f32_bf16 v26, v42, v39
    v_dot2c_f32_bf16 v27, v43, v39
    v_perm_b32 v40, v62, v58, s60
    v_perm_b32 v41, v62, v58, s61
    v_dot2c_f32_bf16 v28, v40, v39
    v_dot2c_f32_bf16 v29, v41, v39
    v_perm_b32 v42, v63, v59, s60
    v_perm_b32 v43, v63, v59, s61
    v_dot2c_f32_bf16 v30, v42, v39
    v_dot2c_f32_bf16 v31, v43, v39
    s_waitcnt vmcnt(6)
    s_cbranch_vccnz L_dy165
    s_cmp_eq_u32 s78, 0
    s_cbranch_scc1 L_dy165n
    s_waitcnt vmcnt(3)
L_dy165n:
    s_waitcnt vmcnt(4)
L_dy165:
    buffer_load_dwordx4 v[172:175], v3, s[44:47], s57 offen nt
    s_add_u32 s57, s57, 0xd000
    s_and_b32 s57, s57, s63
    s_waitcnt lgkmcnt(0)
    ds_read_b128 v[36:39], v5 offset:80
    v_perm_b32 v40, v68, v64, s60
    v_perm_b32 v41, v68, v64, s61
    v_dot2c_f32_bf16 v24, v40, v32
    v_dot2c_f32_bf16 v25, v41, v32
    v_perm_b32 v42, v69, v65, s60
    v_perm_b32 v43, v69, v65, s61
    v_dot2c_f32_bf16 v26, v42, v32
    v_dot2c_f32_bf16 v27, v43, v32
    v_perm_b32 v40, v70, v66, s60
    v_perm_b32 v41, v70, v66, s61
    v_dot2c_f32_bf16 v28, v40, v32
    v_dot2c_f32_bf16 v29, v41, v32
    v_perm_b32 v42, v71, v67, s60
    v_perm_b32 v43, v71, v67, s61
    v_dot2c_f32_bf16 v30, v42, v32
    v_dot2c_f32_bf16 v31, v43, v32
    v_perm_b32 v40, v76, v72, s60
    v_perm_b32 v41, v76, v72, s61
    v_dot2c_f32_bf16 v24, v40, v33
    v_dot2c_f32_bf16 v25, v41, v33
    v_perm_b32 v42, v77, v73, s60
    v_perm_b32 v43, v77, v73, s61
    v_dot2c_f32_bf16 v26, v42, v33
    v_dot2c_f32_bf16 v27, v43, v33
    v_perm_b32 v40, v78, v74, s60
    v_perm_b32 v41, v78, v74, s61
    v_dot2c_f32_bf16 v28, v40, v33
    v_dot2c_f32_bf16 v29, v41, v33
    v_perm_b32 v42, v79, v75, s60
    v_perm_b32 v43, v79, v75, s61
    v_dot2c_f32_bf16 v30, v42, v33
    v_dot2c_f32_bf16 v31, v43, v33
    s_waitcnt vmcnt(6)
    s_cbranch_vccnz L_dy166
    s_cmp_eq_u32 s78, 0
    s_cbranch_scc1 L_dy166n
    s_waitcnt vmcnt(3)
L_dy166n:
    s_waitcnt vmcnt(4)
L_dy166:
    buffer_load_dwordx4 v[176:179], v3, s[44:47], s57 offen nt
    s_addk_i32 s57, 4096
    s_memrealtime s[76:77]
    v_perm_b32 v40, v84, v80, s60
    v_perm_b32 v41, v84, v80, s61
    v_dot2c_f32_bf16 v24, v40, v34
    v_dot2c_f32_bf16 v25, v41, v34
    v_perm_b32 v42, v85, v81, s60
    v_perm_b32 v43, v85, v81, s61
    v_dot2c_f32_bf16 v26, v42, v34
    v_dot2c_f32_bf16 v27, v43, v34
    v_perm_b32 v40, v86, v82, s60
    v_perm_b32 v41, v86, v82, s61
    v_dot2c_f32_bf16 v28, v40, v34
    v_dot2c_f32_bf16 v29, v41, v34
    v_perm_b32 v42, v87, v83, s60
    v_perm_b32 v43, v87, v83, s61
    v_dot2c_f32_bf16 v30, v42, v34
    v_dot2c_f32_bf16 v31, v43, v34
    v_perm_b32 v40, v92, v88, s60
    v_perm_b32 v41, v92, v88, s61
    v_dot2c_f32_bf16 v24, v40, v35
    v_dot2c_f32_bf16 v25, v41, v35
    v_perm_b32 v42, v93, v89, s60
    v_perm_b32 v43, v93, v89, s61
    v_dot2c_f32_bf16 v26, v42, v35
    v_dot2c_f32_bf16 v27, v43, v35
    v_perm_b32 v40, v94, v90, s60
    v_perm_b32 v41, v94, v90, s61
    v_dot2c_f32_bf16 v28, v40, v35
    v_dot2c_f32_bf16 v29, v41, v35
    v_perm_b32 v42, v95, v91, s60
    v_perm_b32 v43, v95, v91, s61
    v_dot2c_f32_bf16 v30, v42, v35
    v_dot2c_f32_bf16 v31, v43, v35
    s_waitcnt vmcnt(6)
    s_cbranch_vccnz L_dy167
    s_cmp_eq_u32 s78, 0
    s_cbranch_scc1 L_dy167n
    s_waitcnt vmcnt(3)
L_dy167n:
    s_waitcnt vmcnt(4)
L_dy167:
    buffer_load_dwordx4 v[180:183], v3, s[44:47], s57 offen nt
    s_addk_i32 s57, 4096
    s_waitcnt lgkmcnt(0)
    s_lshl_b32 s9, s76, 4
    s_sub_u32 s8, s9, s74
    s_cmp_gt_i32 s8, s66
    s_cselect_b64 vcc, -1, 0
    s_cmpk_lt_i32 s8, -480
    s_cselect_b32 s78, 1, 0
    s_add_u32 s74, s74, s68
    s_waitcnt lgkmcnt(0)
    ds_read_b128 v[32:35], v5 offset:96
    v_perm_b32 v40, v100, v96, s60
    v_perm_b32 v41, v100, v96, s61
    v_dot2c_f32_bf16 v24, v40, v36
    v_dot2c_f32_bf16 v25, v41, v36
    v_perm_b32 v42, v101, v97, s60
    v_perm_b32 v43, v101, v97, s61
    v_dot2c_f32_bf16 v26, v42, v36
    v_dot2c_f32_bf16 v27, v43, v36
    v_perm_b32 v40, v102, v98, s60
    v_perm_b32 v41, v102, v98, s61
    v_dot2c_f32_bf16 v28, v40, v36
    v_dot2c_f32_bf16 v29, v41, v36
    v_perm_b32 v42, v103, v99, s60
    v_perm_b32 v43, v103, v99, s61
    v_dot2c_f32_bf16 v30, v42, v36
    v_dot2c_f32_bf16 v31, v43, v36
    v_perm_b32 v40, v108, v104, s60
    v_perm_b32 v41, v108, v104, s61
    v_dot2c_f32_bf16 v24, v40, v37
    v_dot2c_f32_bf16 v25, v41, v37
    v_perm_b32 v42, v109, v105, s60
    v_perm_b32 v43, v109, v105, s61
    v_dot2c_f32_bf16 v26, v42, v37
    v_dot2c_f32_bf16 v27, v43, v37
    v_perm_b32 v40, v110, v106, s60
    v_perm_b32 v41, v110, v106, s61
    v_dot2c_f32_bf16 v28, v40, v37
    v_dot2c_f32_bf16 v29, v41, v37
    v_perm_b32 v42, v111, v107, s60
    v_perm_b32 v43, v111, v107, s61
    v_dot2c_f32_bf16 v30, v42, v37
    v_dot2c_f32_bf16 v31, v43, v37
    s_waitcnt vmcnt(6)
    s_cbranch_vccnz L_dy168
    s_cmp_eq_u32 s78, 0
    s_cbranch_scc1 L_dy168n
    s_waitcnt vmcnt(3)
L_dy168n:
    s_waitcnt vmcnt(4)
L_dy168:
    buffer_load_dwordx4 v[184:187], v3, s[44:47], s57 offen nt
    s_addk_i32 s57, 4096
    v_perm_b32 v40, v116, v112, s60
    v_perm_b32 v41, v116, v112, s61
    v_dot2c_f32_bf16 v24, v40, v38
    v_dot2c_f32_bf16 v25, v41, v38
    v_perm_b32 v42, v117, v113, s60
    v_perm_b32 v43, v117, v113, s61
    v_dot2c_f32_bf16 v26, v42, v38
    v_dot2c_f32_bf16 v27, v43, v38
    v_perm_b32 v40, v118, v114, s60
    v_perm_b32 v41, v118, v114, s61
    v_dot2c_f32_bf16 v28, v40, v38
    v_dot2c_f32_bf16 v29, v41, v38
    v_perm_b32 v42, v119, v115, s60
    v_perm_b32 v43, v119, v115, s61
    v_dot2c_f32_bf16 v30, v42, v38
    v_dot2c_f32_bf16 v31, v43, v38
    v_perm_b32 v40, v124, v120, s60
    v_perm_b32 v41, v124, v120, s61
    v_dot2c_f32_bf16 v24, v40, v39
    v_dot2c_f32_bf16 v25, v41, v39
    v_perm_b32 v42, v125, v121, s60
    v_perm_b32 v43, v125, v121, s61
    v_dot2c_f32_bf16 v26, v42, v39
    v_dot2c_f32_bf16 v27, v43, v39
    v_perm_b32 v40, v126, v122, s60
    v_perm_b32 v41, v126, v122, s61
    v_dot2c_f32_bf16 v28, v40, v39
    v_dot2c_f32_bf16 v29, v41, v39
    v_perm_b32 v42, v127, v123, s60
    v_perm_b32 v43, v127, v123, s61
    v_dot2c_f32_bf16 v30, v42, v39
    v_dot2c_f32_bf16 v31, v43, v39
    s_waitcnt vmcnt(6)
    s_cbranch_vccnz L_dy169
    s_cmp_eq_u32 s78, 0
    s_cbranch_scc1 L_dy169n
    s_waitcnt vmcnt(3)
L_dy169n:
    s_waitcnt vmcnt(4)
L_dy169:
    buffer_load_dwordx4 v[188:191], v3, s[44:47], s57 offen nt
    s_add_u32 s57, s57, 0xd000
    s_and_b32 s57, s57, s63
    s_waitcnt lgkmcnt(0)
    ds_read_b128 v[36:39], v5 offset:112
    v_perm_b32 v40, v132, v128, s60
    v_perm_b32 v41, v132, v128, s61
    v_dot2c_f32_bf16 v24, v40, v32
    v_dot2c_f32_bf16 v25, v41, v32
    v_perm_b32 v42, v133, v129, s60
    v_perm_b32 v43, v133, v129, s61
    v_dot2c_f32_bf16 v26, v42, v32
    v_dot2c_f32_bf16 v27, v43, v32
    v_perm_b32 v40, v134, v130, s60
    v_perm_b32 v41, v134, v130, s61
    v_dot2c_f32_bf16 v28, v40, v32
    v_dot2c_f32_bf16 v29, v41, v32
    v_perm_b32 v42, v135, v131, s60
    v_perm_b32 v43, v135, v131, s61
    v_dot2c_f32_bf16 v30, v42, v32
    v_dot2c_f32_bf16 v31, v43, v32
    v_perm_b32 v40, v140, v136, s60
    v_perm_b32 v41, v140, v136, s61
    v_dot2c_f32_bf16 v24, v40, v33
    v_dot2c_f32_bf16 v25, v41, v33
    v_perm_b32 v42, v141, v137, s60
    v_perm_b32 v43, v141, v137, s61
    v_dot2c_f32_bf16 v26, v42, v33
    v_dot2c_f32_bf16 v27, v43, v33
    v_perm_b32 v40, v142, v138, s60
    v_perm_b32 v41, v142, v138, s61
    v_dot2c_f32_bf16 v28, v40, v33
    v_dot2c_f32_bf16 v29, v41, v33
    v_perm_b32 v42, v143, v139, s60
    v_perm_b32 v43, v143, v139, s61
    v_dot2c_f32_bf16 v30, v42, v33
    v_dot2c_f32_bf16 v31, v43, v33
    s_waitcnt vmcnt(6)
    s_cbranch_vccnz L_dy170
    s_cmp_eq_u32 s78, 0
    s_cbranch_scc1 L_dy170n
    s_waitcnt vmcnt(3)
L_dy170n:
    s_waitcnt vmcnt(4)
L_dy170:
    buffer_load_dwordx4 v[192:195], v3, s[44:47], s57 offen nt
    s_addk_i32 s57, 4096
    s_memrealtime s[76:77]
    v_perm_b32 v40, v148, v144, s60
    v_perm_b32 v41, v148, v144, s61
    v_dot2c_f32_bf16 v24, v40, v34
    v_dot2c_f32_bf16 v25, v41, v34
    v_perm_b32 v42, v149, v145, s60
    v_perm_b32 v43, v149, v145, s61
    v_dot2c_f32_bf16 v26, v42, v34
    v_dot2c_f32_bf16 v27, v43, v34
    v_perm_b32 v40, v150, v146, s60
    v_perm_b32 v41, v150, v146, s61
    v_dot2c_f32_bf16 v28, v40, v34
    v_dot2c_f32_bf16 v29, v41, v34
    v_perm_b32 v42, v151, v147, s60
    v_perm_b32 v43, v151, v147, s61
    v_dot2c_f32_bf16 v30, v42, v34
    v_dot2c_f32_bf16 v31, v43, v34
    v_perm_b32 v40, v156, v152, s60
    v_perm_b32 v41, v156, v152, s61
    v_dot2c_f32_bf16 v24, v40, v35
    v_dot2c_f32_bf16 v25, v41, v35
    v_perm_b32 v42, v157, v153, s60
    v_perm_b32 v43, v157, v153, s61
    v_dot2c_f32_bf16 v26, v42, v35
    v_dot2c_f32_bf16 v27, v43, v35
    v_perm_b32 v40, v158, v154, s60
    v_perm_b32 v41, v158, v154, s61
    v_dot2c_f32_bf16 v28, v40, v35
    v_dot2c_f32_bf16 v29, v41, v35
    v_perm_b32 v42, v159, v155, s60
    v_perm_b32 v43, v159, v155, s61
    v_dot2c_f32_bf16 v30, v42, v35
    v_dot2c_f32_bf16 v31, v43, v35
    s_waitcnt vmcnt(6)
    s_cbranch_vccnz L_dy171
    s_cmp_eq_u32 s78, 0
    s_cbranch_scc1 L_dy171n
    s_waitcnt vmcnt(3)
L_dy171n:
    s_waitcnt vmcnt(4)
L_dy171:
    buffer_load_dwordx4 v[196:199], v3, s[44:47], s57 offen nt
    s_addk_i32 s57, 4096
    s_waitcnt lgkmcnt(0)
    s_cmp_lg_u32 s58, 0
    s_cbranch_scc1 L_pb172
    s_or_b32 s8, s76, 1
    v_mov_b32 v47, s8
    s_mov_b64 exec, 1
    buffer_store_dword v47, off, s[52:55], s59 offset:192 sc1
    s_mov_b64 exec, -1
L_pb172:
    s_lshl_b32 s9, s76, 4
    s_sub_u32 s8, s9, s74
    s_cmp_gt_i32 s8, s66
    s_cselect_b64 vcc, -1, 0
    s_cmpk_lt_i32 s8, -480
    s_cselect_b32 s78, 1, 0
    s_add_u32 s74, s74, s68
    s_waitcnt lgkmcnt(0)
    ds_read_b128 v[32:35], v5 offset:128
    v_perm_b32 v40, v164, v160, s60
    v_perm_b32 v41, v164, v160, s61
    v_dot2c_f32_bf16 v24, v40, v36
    v_dot2c_f32_bf16 v25, v41, v36
    v_perm_b32 v42, v165, v161, s60
    v_perm_b32 v43, v165, v161, s61
    v_dot2c_f32_bf16 v26, v42, v36
    v_dot2c_f32_bf16 v27, v43, v36
    v_perm_b32 v40, v166, v162, s60
    v_perm_b32 v41, v166, v162, s61
    v_dot2c_f32_bf16 v28, v40, v36
    v_dot2c_f32_bf16 v29, v41, v36
    v_perm_b32 v42, v167, v163, s60
    v_perm_b32 v43, v167, v163, s61
    v_dot2c_f32_bf16 v30, v42, v36
    v_dot2c_f32_bf16 v31, v43, v36
    s_waitcnt vmcnt(6)
    s_cbranch_vccnz L_dy173
    s_cmp_eq_u32 s78, 0
    s_cbranch_scc1 L_dy173n
    s_waitcnt vmcnt(3)
L_dy173n:
    s_waitcnt vmcnt(4)
L_dy173:
    buffer_load_dwordx4 v[200:203], v3, s[44:47], s57 offen nt
    s_addk_i32 s57, 4096
    v_perm_b32 v40, v172, v168, s60
    v_perm_b32 v41, v172, v168, s61
    v_dot2c_f32_bf16 v24, v40, v37
    v_dot2c_f32_bf16 v25, v41, v37
    v_perm_b32 v42, v173, v169, s60
    v_perm_b32 v43, v173, v169, s61
    v_dot2c_f32_bf16 v26, v42, v37
    v_dot2c_f32_bf16 v27, v43, v37
    v_perm_b32 v40, v174, v170, s60
    v_perm_b32 v41, v174, v170, s61
    v_dot2c_f32_bf16 v28, v40, v37
    v_dot2c_f32_bf16 v29, v41, v37
    v_perm_b32 v42, v175, v171, s60
    v_perm_b32 v43, v175, v171, s61
    v_dot2c_f32_bf16 v30, v42, v37
    v_dot2c_f32_bf16 v31, v43, v37
    s_waitcnt vmcnt(6)
    s_cbranch_vccnz L_dy174
    s_cmp_eq_u32 s78, 0
    s_cbranch_scc1 L_dy174n
    s_waitcnt vmcnt(3)
L_dy174n:
    s_waitcnt vmcnt(4)
L_dy174:
    buffer_load_dwordx4 v[204:207], v3, s[44:47], s57 offen nt
    s_add_u32 s57, s57, 0xd000
    s_and_b32 s57, s57, s63
    s_waitcnt vmcnt(6)
    s_cbranch_vccnz L_dy175
    s_cmp_eq_u32 s78, 0
    s_cbranch_scc1 L_dy175n
    s_waitcnt vmcnt(3)
L_dy175n:
    s_waitcnt vmcnt(4)
L_dy175:
    buffer_load_dwordx4 v[208:211], v3, s[44:47], s57 offen nt
    s_addk_i32 s57, 4096
    s_memrealtime s[76:77]
    v_perm_b32 v40, v180, v176, s60
    v_perm_b32 v41, v180, v176, s61
    v_dot2c_f32_bf16 v24, v40, v38
    v_dot2c_f32_bf16 v25, v41, v38
    v_perm_b32 v42, v181, v177, s60
    v_perm_b32 v43, v181, v177, s61
    v_dot2c_f32_bf16 v26, v42, v38
    v_dot2c_f32_bf16 v27, v43, v38
    v_perm_b32 v40, v182, v178, s60
    v_perm_b32 v41, v182, v178, s61
    v_dot2c_f32_bf16 v28, v40, v38
    v_dot2c_f32_bf16 v29, v41, v38
    v_perm_b32 v42, v183, v179, s60
    v_perm_b32 v43, v183, v179, s61
    v_dot2c_f32_bf16 v30, v42, v38
    v_dot2c_f32_bf16 v31, v43, v38
    s_waitcnt vmcnt(6)
    s_cbranch_vccnz L_dy176
    s_cmp_eq_u32 s78, 0
    s_cbranch_scc1 L_dy176n
    s_waitcnt vmcnt(3)
L_dy176n:
    s_waitcnt vmcnt(4)
L_dy176:
    buffer_load_dwordx4 v[212:215], v3, s[44:47], s57 offen nt
    s_addk_i32 s57, 4096
    s_waitcnt lgkmcnt(0)
    s_lshl_b32 s9, s76, 4
    s_sub_u32 s8, s9, s74
    s_cmp_gt_i32 s8, s66
    s_cselect_b64 vcc, -1, 0
    s_cmpk_lt_i32 s8, -480
    s_cselect_b32 s78, 1, 0
    s_add_u32 s74, s74, s68
    s_waitcnt vmcnt(6)
    s_cbranch_vccnz L_dy177
    s_cmp_eq_u32 s78, 0
    s_cbranch_scc1 L_dy177n
    s_waitcnt vmcnt(3)
L_dy177n:
    s_waitcnt vmcnt(4)
L_dy177:
    buffer_load_dwordx4 v[216:219], v3, s[44:47], s57 offen nt
    s_addk_i32 s57, 4096
    v_perm_b32 v40, v188, v184, s60
    v_perm_b32 v41, v188, v184, s61
    v_dot2c_f32_bf16 v24, v40, v39
    v_dot2c_f32_bf16 v25, v41, v39
    v_perm_b32 v42, v189, v185, s60
    v_perm_b32 v43, v189, v185, s61
    v_dot2c_f32_bf16 v26, v42, v39
    v_dot2c_f32_bf16 v27, v43, v39
    v_perm_b32 v40, v190, v186, s60
    v_perm_b32 v41, v190, v186, s61
    v_dot2c_f32_bf16 v28, v40, v39
    v_dot2c_f32_bf16 v29, v41, v39
    v_perm_b32 v42, v191, v187, s60
    v_perm_b32 v43, v191, v187, s61
    v_dot2c_f32_bf16 v30, v42, v39
    v_dot2c_f32_bf16 v31, v43, v39
    s_waitcnt vmcnt(6)
    s_cbranch_vccnz L_dy178
    s_cmp_eq_u32 s78, 0
    s_cbranch_scc1 L_dy178n
    s_waitcnt vmcnt(3)
L_dy178n:
    s_waitcnt vmcnt(4)
L_dy178:
    buffer_load_dwordx4 v[220:223], v3, s[44:47], s57 offen nt
    s_add_u32 s57, s57, 0xd000
    s_and_b32 s57, s57, s63
    s_waitcnt vmcnt(6)
    s_cbranch_vccnz L_dy179
    s_cmp_eq_u32 s78, 0
    s_cbranch_scc1 L_dy179n
    s_waitcnt vmcnt(3)
L_dy179n:
    s_waitcnt vmcnt(4)
L_dy179:
    buffer_load_dwordx4 v[224:227], v3, s[44:47], s57 offen nt
    s_addk_i32 s57, 4096
    s_memrealtime s[76:77]
    s_waitcnt lgkmcnt(0)
    ds_read_b128 v[36:39], v5 offset:144
    v_perm_b32 v40, v196, v192, s60
    v_perm_b32 v41, v196, v192, s61
    v_dot2c_f32_bf16 v24, v40, v32
    v_dot2c_f32_bf16 v25, v41, v32
    v_perm_b32 v42, v197, v193, s60
    v_perm_b32 v43, v197, v193, s61
    v_dot2c_f32_bf16 v26, v42, v32
    v_dot2c_f32_bf16 v27, v43, v32
    v_perm_b32 v40, v198, v194, s60
    v_perm_b32 v41, v198, v194, s61
    v_dot2c_f32_bf16 v28, v40, v32
    v_dot2c_f32_bf16 v29, v41, v32
    v_perm_b32 v42, v199, v195, s60
    v_perm_b32 v43, v199, v195, s61
    v_dot2c_f32_bf16 v30, v42, v32
    v_dot2c_f32_bf16 v31, v43, v32
    s_waitcnt vmcnt(6)
    s_cbranch_vccnz L_dy180
    s_cmp_eq_u32 s78, 0
    s_cbranch_scc1 L_dy180n
    s_waitcnt vmcnt(3)
L_dy180n:
    s_waitcnt vmcnt(4)
L_dy180:
    buffer_load_dwordx4 v[228:231], v3, s[44:47], s57 offen nt
    s_addk_i32 s57, 4096
    s_waitcnt lgkmcnt(0)
    s_lshl_b32 s9, s76, 4
    s_sub_u32 s8, s9, s74
    s_cmp_gt_i32 s8, s66
    s_cselect_b64 vcc, -1, 0
    s_cmpk_lt_i32 s8, -480
    s_cselect_b32 s78, 1, 0
    s_add_u32 s74, s74, s68
    s_waitcnt vmcnt(6)
    s_cbranch_vccnz L_dy181
    s_cmp_eq_u32 s78, 0
    s_cbranch_scc1 L_dy181n
    s_waitcnt vmcnt(3)
L_dy181n:
    s_waitcnt vmcnt(4)
L_dy181:
    buffer_load_dwordx4 v[232:235], v3, s[44:47], s57 offen nt
    s_addk_i32 s57, 4096
    v_perm_b32 v40, v204, v200, s60
    v_perm_b32 v41, v204, v200, s61
    v_dot2c_f32_bf16 v24, v40, v33
    v_dot2c_f32_bf16 v25, v41, v33
    v_perm_b32 v42, v205, v201, s60
    v_perm_b32 v43, v205, v201, s61
    v_dot2c_f32_bf16 v26, v42, v33
    v_dot2c_f32_bf16 v27, v43, v33
    v_perm_b32 v40, v206, v202, s60
    v_perm_b32 v41, v206, v202, s61
    v_dot2c_f32_bf16 v28, v40, v33
    v_dot2c_f32_bf16 v29, v41, v33
    v_perm_b32 v42, v207, v203, s60
    v_perm_b32 v43, v207, v203, s61
    v_dot2c_f32_bf16 v30, v42, v33
    v_dot2c_f32_bf16 v31, v43, v33
    s_waitcnt vmcnt(6)
    s_cbranch_vccnz L_dy182
    s_cmp_eq_u32 s78, 0
    s_cbranch_scc1 L_dy182n
    s_waitcnt vmcnt(3)
L_dy182n:
    s_waitcnt vmcnt(4)
L_dy182:
    buffer_load_dwordx4 v[236:239], v3, s[44:47], s57 offen nt
    s_add_u32 s57, s57, 0xd000
    s_and_b32 s57, s57, s63
    s_waitcnt vmcnt(6)
    s_cbranch_vccnz L_dy183
    s_cmp_eq_u32 s78, 0
    s_cbranch_scc1 L_dy183n
    s_waitcnt vmcnt(3)
L_dy183n:
    s_waitcnt vmcnt(4)
L_dy183:
    buffer_load_dwordx4 v[240:243], v3, s[44:47], s57 offen nt
    s_addk_i32 s57, 4096
    s_memrealtime s[76:77]
    v_perm_b32 v40, v212, v208, s60
    v_perm_b32 v41, v212, v208, s61
    v_dot2c_f32_bf16 v24, v40, v34
    v_dot2c_f32_bf16 v25, v41, v34
    v_perm_b32 v42, v213, v209, s60
    v_perm_b32 v43, v213, v209, s61
    v_dot2c_f32_bf16 v26, v42, v34
    v_dot2c_f32_bf16 v27, v43, v34
    v_perm_b32 v40, v214, v210, s60
    v_perm_b32 v41, v214, v210, s61
    v_dot2c_f32_bf16 v28, v40, v34
    v_dot2c_f32_bf16 v29, v41, v34
    v_perm_b32 v42, v215, v211, s60
    v_perm_b32 v43, v215, v211, s61
    v_dot2c_f32_bf16 v30, v42, v34
    v_dot2c_f32_bf16 v31, v43, v34
    s_waitcnt vmcnt(6)
    s_cbranch_vccnz L_dy184
    s_cmp_eq_u32 s78, 0
    s_cbranch_scc1 L_dy184n
    s_waitcnt vmcnt(3)
L_dy184n:
    s_waitcnt vmcnt(4)
L_dy184:
    buffer_load_dwordx4 v[244:247], v3, s[44:47], s57 offen nt
    s_addk_i32 s57, 4096
    s_waitcnt lgkmcnt(0)
    s_lshl_b32 s9, s76, 4
    s_sub_u32 s8, s9, s74
    s_cmp_gt_i32 s8, s66
    s_cselect_b64 vcc, -1, 0
    s_cmpk_lt_i32 s8, -480
    s_cselect_b32 s78, 1, 0
    s_add_u32 s74, s74, s68
    s_waitcnt vmcnt(6)
    s_cbranch_vccnz L_dy185
    s_cmp_eq_u32 s78, 0
    s_cbranch_scc1 L_dy185n
    s_waitcnt vmcnt(3)
L_dy185n:
    s_waitcnt vmcnt(4)
L_dy185:
    buffer_load_dwordx4 v[248:251], v3, s[44:47], s57 offen nt
    s_addk_i32 s57, 4096
    v_perm_b32 v40, v220, v216, s60
    v_perm_b32 v41, v220, v216, s61
    v_dot2c_f32_bf16 v24, v40, v35
    v_dot2c_f32_bf16 v25, v41, v35
    v_perm_b32 v42, v221, v217, s60
    v_perm_b32 v43, v221, v217, s61
    v_dot2c_f32_bf16 v26, v42, v35
    v_dot2c_f32_bf16 v27, v43, v35
    v_perm_b32 v40, v222, v218, s60
    v_perm_b32 v41, v222, v218, s61
    v_dot2c_f32_bf16 v28, v40, v35
    v_dot2c_f32_bf16 v29, v41, v35
    v_perm_b32 v42, v223, v219, s60
    v_perm_b32 v43, v223, v219, s61
    v_dot2c_f32_bf16 v30, v42, v35
    v_dot2c_f32_bf16 v31, v43, v35
    s_waitcnt vmcnt(6)
    s_cbranch_vccnz L_dy186
    s_cmp_eq_u32 s78, 0
    s_cbranch_scc1 L_dy186n
    s_waitcnt vmcnt(3)
L_dy186n:
    s_waitcnt vmcnt(4)
L_dy186:
    buffer_load_dwordx4 v[252:255], v3, s[44:47], s57 offen nt
    s_add_u32 s57, s57, 0xd000
    s_and_b32 s57, s57, s63
    s_waitcnt vmcnt(6)
    s_cbranch_vccnz L_dy187
    s_cmp_eq_u32 s78, 0
    s_cbranch_scc1 L_dy187n
    s_waitcnt vmcnt(3)
L_dy187n:
    s_waitcnt vmcnt(4)
L_dy187:
    buffer_load_dwordx4 v[48:51], v3, s[44:47], s57 offen nt
    s_addk_i32 s57, 4096
    s_memrealtime s[76:77]
    s_waitcnt lgkmcnt(0)
    ds_read_b128 v[32:35], v5 offset:160
    v_perm_b32 v40, v228, v224, s60
    v_perm_b32 v41, v228, v224, s61
    v_dot2c_f32_bf16 v24, v40, v36
    v_dot2c_f32_bf16 v25, v41, v36
    v_perm_b32 v42, v229, v225, s60
    v_perm_b32 v43, v229, v225, s61
    v_dot2c_f32_bf16 v26, v42, v36
    v_dot2c_f32_bf16 v27, v43, v36
    v_perm_b32 v40, v230, v226, s60
    v_perm_b32 v41, v230, v226, s61
    v_dot2c_f32_bf16 v28, v40, v36
    v_dot2c_f32_bf16 v29, v41, v36
    v_perm_b32 v42, v231, v227, s60
    v_perm_b32 v43, v231, v227, s61
    v_dot2c_f32_bf16 v30, v42, v36
    v_dot2c_f32_bf16 v31, v43, v36
    s_waitcnt vmcnt(6)
    s_cbranch_vccnz L_dy188
    s_cmp_eq_u32 s78, 0
    s_cbranch_scc1 L_dy188n
    s_waitcnt vmcnt(3)
L_dy188n:
    s_waitcnt vmcnt(4)
L_dy188:
    buffer_load_dwordx4 v[52:55], v3, s[44:47], s57 offen nt
    s_addk_i32 s57, 4096
    s_waitcnt lgkmcnt(0)
    s_lshl_b32 s9, s76, 4
    s_sub_u32 s8, s9, s74
    s_cmp_gt_i32 s8, s66
    s_cselect_b64 vcc, -1, 0
    s_cmpk_lt_i32 s8, -480
    s_cselect_b32 s78, 1, 0
    s_add_u32 s74, s74, s68
    s_waitcnt vmcnt(6)
    s_cbranch_vccnz L_dy189
    s_cmp_eq_u32 s78, 0
    s_cbranch_scc1 L_dy189n
    s_waitcnt vmcnt(3)
L_dy189n:
    s_waitcnt vmcnt(4)
L_dy189:
    buffer_load_dwordx4 v[56:59], v3, s[44:47], s57 offen nt
    s_addk_i32 s57, 4096
    s_load_dwordx8 s[20:27], s[36:37], 192
    v_perm_b32 v40, v236, v232, s60
    v_perm_b32 v41, v236, v232, s61
    v_dot2c_f32_bf16 v24, v40, v37
    v_dot2c_f32_bf16 v25, v41, v37
    v_perm_b32 v42, v237, v233, s60
    v_perm_b32 v43, v237, v233, s61
    v_dot2c_f32_bf16 v26, v42, v37
    v_dot2c_f32_bf16 v27, v43, v37
    v_perm_b32 v40, v238, v234, s60
    v_perm_b32 v41, v238, v234, s61
    v_dot2c_f32_bf16 v28, v40, v37
    v_dot2c_f32_bf16 v29, v41, v37
    v_perm_b32 v42, v239, v235, s60
    v_perm_b32 v43, v239, v235, s61
    v_dot2c_f32_bf16 v30, v42, v37
    v_dot2c_f32_bf16 v31, v43, v37
    s_waitcnt vmcnt(6)
    s_cbranch_vccnz L_dy190
    s_cmp_eq_u32 s78, 0
    s_cbranch_scc1 L_dy190n
    s_waitcnt vmcnt(3)
L_dy190n:
    s_waitcnt vmcnt(4)
L_dy190:
    buffer_load_dwordx4 v[60:63], v3, s[44:47], s57 offen nt
    s_add_u32 s57, s57, 0xd000
    s_and_b32 s57, s57, s63
    s_waitcnt vmcnt(6)
    s_cbranch_vccnz L_dy191
    s_cmp_eq_u32 s78, 0
    s_cbranch_scc1 L_dy191n
    s_waitcnt vmcnt(3)
L_dy191n:
    s_waitcnt vmcnt(4)
L_dy191:
    buffer_load_dwordx4 v[64:67], v3, s[44:47], s57 offen nt
    s_addk_i32 s57, 4096
    v_perm_b32 v40, v244, v240, s60
    v_perm_b32 v41, v244, v240, s61
    v_dot2c_f32_bf16 v24, v40, v38
    v_dot2c_f32_bf16 v25, v41, v38
    v_perm_b32 v42, v245, v241, s60
    v_perm_b32 v43, v245, v241, s61
    v_dot2c_f32_bf16 v26, v42, v38
    v_dot2c_f32_bf16 v27, v43, v38
    v_perm_b32 v40, v246, v242, s60
    v_perm_b32 v41, v246, v242, s61
    v_dot2c_f32_bf16 v28, v40, v38
    v_dot2c_f32_bf16 v29, v41, v38
    v_perm_b32 v42, v247, v243, s60
    v_perm_b32 v43, v247, v243, s61
    v_dot2c_f32_bf16 v30, v42, v38
    v_dot2c_f32_bf16 v31, v43, v38
    s_waitcnt vmcnt(6)
    s_cbranch_vccnz L_dy192
    s_cmp_eq_u32 s78, 0
    s_cbranch_scc1 L_dy192n
    s_waitcnt vmcnt(3)
L_dy192n:
    s_waitcnt vmcnt(4)
L_dy192:
    buffer_load_dwordx4 v[68:71], v3, s[44:47], s57 offen nt
    s_addk_i32 s57, 4096
    s_waitcnt vmcnt(6)
    s_cbranch_vccnz L_dy193
    s_cmp_eq_u32 s78, 0
    s_cbranch_scc1 L_dy193n
    s_waitcnt vmcnt(3)
L_dy193n:
    s_waitcnt vmcnt(4)
L_dy193:
    buffer_load_dwordx4 v[72:75], v3, s[44:47], s57 offen nt
    s_addk_i32 s57, 4096
    v_perm_b32 v40, v252, v248, s60
    v_perm_b32 v41, v252, v248, s61
    v_dot2c_f32_bf16 v24, v40, v39
    v_dot2c_f32_bf16 v25, v41, v39
    v_perm_b32 v42, v253, v249, s60
    v_perm_b32 v43, v253, v249, s61
    v_dot2c_f32_bf16 v26, v42, v39
    v_dot2c_f32_bf16 v27, v43, v39
    v_perm_b32 v40, v254, v250, s60
    v_perm_b32 v41, v254, v250, s61
    v_dot2c_f32_bf16 v28, v40, v39
    v_dot2c_f32_bf16 v29, v41, v39
    v_perm_b32 v42, v255, v251, s60
    v_perm_b32 v43, v255, v251, s61
    v_dot2c_f32_bf16 v30, v42, v39
    v_dot2c_f32_bf16 v31, v43, v39
    s_waitcnt vmcnt(6)
    s_cbranch_vccnz L_dy194
    s_cmp_eq_u32 s78, 0
    s_cbranch_scc1 L_dy194n
    s_waitcnt vmcnt(3)
L_dy194n:
    s_waitcnt vmcnt(4)
L_dy194:
    buffer_load_dwordx4 v[76:79], v3, s[44:47], s57 offen nt
    s_add_u32 s57, s57, 0xd000
    s_and_b32 s57, s57, s63
    s_waitcnt vmcnt(6)
    s_cbranch_vccnz L_dy195
    s_cmp_eq_u32 s78, 0
    s_cbranch_scc1 L_dy195n
    s_waitcnt vmcnt(3)
L_dy195n:
    s_waitcnt vmcnt(4)
L_dy195:
    buffer_load_dwordx4 v[80:83], v3, s[44:47], s57 offen nt
    s_addk_i32 s57, 4096
    s_movk_i32 s66, 800
    s_cmp_eq_u32 s6, 3
    s_cselect_b32 s66, 0, s66
    s_memrealtime s[76:77]
    s_waitcnt lgkmcnt(0)
    ds_read_b128 v[36:39], v5 offset:176
    v_perm_b32 v40, v52, v48, s60
    v_perm_b32 v41, v52, v48, s61
    v_dot2c_f32_bf16 v24, v40, v32
    v_dot2c_f32_bf16 v25, v41, v32
    v_perm_b32 v42, v53, v49, s60
    v_perm_b32 v43, v53, v49, s61
    v_dot2c_f32_bf16 v26, v42, v32
    v_dot2c_f32_bf16 v27, v43, v32
    v_perm_b32 v40, v54, v50, s60
    v_perm_b32 v41, v54, v50, s61
    v_dot2c_f32_bf16 v28, v40, v32
    v_dot2c_f32_bf16 v29, v41, v32
    v_perm_b32 v42, v55, v51, s60
    v_perm_b32 v43, v55, v51, s61
    v_dot2c_f32_bf16 v30, v42, v32
    v_dot2c_f32_bf16 v31, v43, v32
    s_waitcnt vmcnt(6)
    s_cbranch_vccnz L_dy196
    s_cmp_eq_u32 s78, 0
    s_cbranch_scc1 L_dy196n
    s_waitcnt vmcnt(3)
L_dy196n:
    s_waitcnt vmcnt(4)
L_dy196:
    buffer_load_dwordx4 v[84:87], v3, s[44:47], s57 offen nt
    s_addk_i32 s57, 4096
    s_waitcnt lgkmcnt(0)
    s_mov_b32 s75, 0
    s_sub_u32 s8, s20, s76
    s_cmp_eq_u32 s20, 0
    s_cselect_b32 s8, 0, s8
    s_add_u32 s75, s75, s8
    s_sub_u32 s8, s21, s76
    s_cmp_eq_u32 s21, 0
    s_cselect_b32 s8, 0, s8
    s_add_u32 s75, s75, s8
    s_sub_u32 s8, s22, s76
    s_cmp_eq_u32 s22, 0
    s_cselect_b32 s8, 0, s8
    s_add_u32 s75, s75, s8
    s_sub_u32 s8, s23, s76
    s_cmp_eq_u32 s23, 0
    s_cselect_b32 s8, 0, s8
    s_add_u32 s75, s75, s8
    s_sub_u32 s8, s24, s76
    s_cmp_eq_u32 s24, 0
    s_cselect_b32 s8, 0, s8
    s_add_u32 s75, s75, s8
    s_sub_u32 s8, s25, s76
    s_cmp_eq_u32 s25, 0
    s_cselect_b32 s8, 0, s8
    s_add_u32 s75, s75, s8
    s_sub_u32 s8, s26, s76
    s_cmp_eq_u32 s26, 0
    s_cselect_b32 s8, 0, s8
    s_add_u32 s75, s75, s8
    s_sub_u32 s8, s27, s76
    s_cmp_eq_u32 s27, 0
    s_cselect_b32 s8, 0, s8
    s_add_u32 s75, s75, s8
    s_lshl_b32 s74, s76, 4
    s_lshl_b32 s75, s75, 1
    s_add_u32 s74, s74, s75
    s_sub_u32 s68, s74, s69
    s_mul_i32 s68, s68, 998
    s_lshr_b32 s68, s68, 16
    s_max_u32 s68, s68, 214
    s_min_u32 s68, s68, 256
    s_mov_b32 s69, s74
    s_mul_i32 s8, s68, 24
    s_add_u32 s74, s74, s8
    s_mul_i32 s68, s68, 2
    s_lshl_b32 s9, s76, 4
    s_sub_u32 s8, s9, s74
    s_cmp_gt_i32 s8, s66
    s_cselect_b64 vcc, -1, 0
    s_cmpk_lt_i32 s8, -160
    s_cselect_b32 s78, 1, 0
    s_add_u32 s74, s74, s68
    s_waitcnt vmcnt(6)
    s_cbranch_vccnz L_dy197
    s_cmp_eq_u32 s78, 0
    s_cbranch_scc1 L_dy197n
    s_waitcnt vmcnt(3)
L_dy197n:
    s_waitcnt vmcnt(4)
L_dy197:
    buffer_load_dwordx4 v[88:91], v3, s[44:47], s57 offen nt
    s_addk_i32 s57, 4096
    s_memrealtime s[76:77]
    v_perm_b32 v40, v60, v56, s60
    v_perm_b32 v41, v60, v56, s61
    v_dot2c_f32_bf16 v24, v40, v33
    v_dot2c_f32_bf16 v25, v41, v33
    v_perm_b32 v42, v61, v57, s60
    v_perm_b32 v43, v61, v57, s61
    v_dot2c_f32_bf16 v26, v42, v33
    v_dot2c_f32_bf16 v27, v43, v33
    v_perm_b32 v40, v62, v58, s60
    v_perm_b32 v41, v62, v58, s61
    v_dot2c_f32_bf16 v28, v40, v33
    v_dot2c_f32_bf16 v29, v41, v33
    v_perm_b32 v42, v63, v59, s60
    v_perm_b32 v43, v63, v59, s61
    v_dot2c_f32_bf16 v30, v42, v33
    v_dot2c_f32_bf16 v31, v43, v33
    s_waitcnt vmcnt(6)
    s_cbranch_vccnz L_dy198
    s_cmp_eq_u32 s78, 0
    s_cbranch_scc1 L_dy198n
    s_waitcnt vmcnt(3)
L_dy198n:
    s_waitcnt vmcnt(4)
L_dy198:
    buffer_load_dwordx4 v[92:95], v3, s[44:47], s57 offen nt
    s_add_u32 s57, s57, 0xd000
    s_and_b32 s57, s57, s63
    s_waitcnt lgkmcnt(0)
    s_lshl_b32 s9, s76, 4
    s_sub_u32 s8, s9, s74
    s_cmp_gt_i32 s8, s66
    s_cselect_b64 vcc, -1, 0
    s_cmpk_lt_i32 s8, -160
    s_cselect_b32 s78, 1, 0
    s_add_u32 s74, s74, s68
    s_waitcnt vmcnt(6)
    s_cbranch_vccnz L_dy199
    s_cmp_eq_u32 s78, 0
    s_cbranch_scc1 L_dy199n
    s_waitcnt vmcnt(3)
L_dy199n:
    s_waitcnt vmcnt(4)
L_dy199:
    buffer_load_dwordx4 v[96:99], v3, s[44:47], s57 offen nt
    s_addk_i32 s57, 4096
    s_memrealtime s[76:77]
    v_perm_b32 v40, v68, v64, s60
    v_perm_b32 v41, v68, v64, s61
    v_dot2c_f32_bf16 v24, v40, v34
    v_dot2c_f32_bf16 v25, v41, v34
    v_perm_b32 v42, v69, v65, s60
    v_perm_b32 v43, v69, v65, s61
    v_dot2c_f32_bf16 v26, v42, v34
    v_dot2c_f32_bf16 v27, v43, v34
    v_perm_b32 v40, v70, v66, s60
    v_perm_b32 v41, v70, v66, s61
    v_dot2c_f32_bf16 v28, v40, v34
    v_dot2c_f32_bf16 v29, v41, v34
    v_perm_b32 v42, v71, v67, s60
    v_perm_b32 v43, v71, v67, s61
    v_dot2c_f32_bf16 v30, v42, v34
    v_dot2c_f32_bf16 v31, v43, v34
    s_waitcnt vmcnt(6)
    s_cbranch_vccnz L_dy200
    s_cmp_eq_u32 s78, 0
    s_cbranch_scc1 L_dy200n
    s_waitcnt vmcnt(3)
L_dy200n:
    s_waitcnt vmcnt(4)
L_dy200:
    buffer_load_dwordx4 v[100:103], v3, s[44:47], s57 offen nt
    s_addk_i32 s57, 4096
    s_waitcnt lgkmcnt(0)
    s_lshl_b32 s9, s76, 4
    s_sub_u32 s8, s9, s74
    s_cmp_gt_i32 s8, s66
    s_cselect_b64 vcc, -1, 0
    s_cmpk_lt_i32 s8, -160
    s_cselect_b32 s78, 1, 0
    s_add_u32 s74, s74, s68
    s_waitcnt vmcnt(6)
    s_cbranch_vccnz L_dy201
    s_cmp_eq_u32 s78, 0
    s_cbranch_scc1 L_dy201n
    s_waitcnt vmcnt(3)
L_dy201n:
    s_waitcnt vmcnt(4)
L_dy201:
    buffer_load_dwordx4 v[104:107], v3, s[44:47], s57 offen nt
    s_addk_i32 s57, 4096
    s_memrealtime s[76:77]
    v_perm_b32 v40, v76, v72, s60
    v_perm_b32 v41, v76, v72, s61
    v_dot2c_f32_bf16 v24, v40, v35
    v_dot2c_f32_bf16 v25, v41, v35
    v_perm_b32 v42, v77, v73, s60
    v_perm_b32 v43, v77, v73, s61
    v_dot2c_f32_bf16 v26, v42, v35
    v_dot2c_f32_bf16 v27, v43, v35
    v_perm_b32 v40, v78, v74, s60
    v_perm_b32 v41, v78, v74, s61
    v_dot2c_f32_bf16 v28, v40, v35
    v_dot2c_f32_bf16 v29, v41, v35
    v_perm_b32 v42, v79, v75, s60
    v_perm_b32 v43, v79, v75, s61
    v_dot2c_f32_bf16 v30, v42, v35
    v_dot2c_f32_bf16 v31, v43, v35
    s_waitcnt vmcnt(6)
    s_cbranch_vccnz L_dy202
    s_cmp_eq_u32 s78, 0
    s_cbranch_scc1 L_dy202n
    s_waitcnt vmcnt(3)
L_dy202n:
    s_waitcnt vmcnt(4)
L_dy202:
    buffer_load_dwordx4 v[108:111], v3, s[44:47], s57 offen nt
    s_add_u32 s57, s57, 0xd000
    s_and_b32 s57, s57, s63
    s_waitcnt lgkmcnt(0)
    s_lshl_b32 s9, s76, 4
    s_sub_u32 s8, s9, s74
    s_cmp_gt_i32 s8, s66
    s_cselect_b64 vcc, -1, 0
    s_cmpk_lt_i32 s8, -160
    s_cselect_b32 s78, 1, 0
    s_add_u32 s74, s74, s68
    s_waitcnt vmcnt(6)
    s_cbranch_vccnz L_dy203
    s_cmp_eq_u32 s78, 0
    s_cbranch_scc1 L_dy203n
    s_waitcnt vmcnt(3)
L_dy203n:
    s_waitcnt vmcnt(4)
L_dy203:
    buffer_load_dwordx4 v[112:115], v3, s[44:47], s57 offen nt
    s_addk_i32 s57, 4096
    s_memrealtime s[76:77]
    s_waitcnt lgkmcnt(0)
    ds_read_b128 v[32:35], v5 offset:192
    v_perm_b32 v40, v84, v80, s60
    v_perm_b32 v41, v84, v80, s61
    v_dot2c_f32_bf16 v24, v40, v36
    v_dot2c_f32_bf16 v25, v41, v36
    v_perm_b32 v42, v85, v81, s60
    v_perm_b32 v43, v85, v81, s61
    v_dot2c_f32_bf16 v26, v42, v36
    v_dot2c_f32_bf16 v27, v43, v36
    v_perm_b32 v40, v86, v82, s60
    v_perm_b32 v41, v86, v82, s61
    v_dot2c_f32_bf16 v28, v40, v36
    v_dot2c_f32_bf16 v29, v41, v36
    v_perm_b32 v42, v87, v83, s60
    v_perm_b32 v43, v87, v83, s61
    v_dot2c_f32_bf16 v30, v42, v36
    v_dot2c_f32_bf16 v31, v43, v36
    s_waitcnt vmcnt(6)
    s_cbranch_vccnz L_dy204
    s_cmp_eq_u32 s78, 0
    s_cbranch_scc1 L_dy204n
    s_waitcnt vmcnt(3)
L_dy204n:
    s_waitcnt vmcnt(4)
L_dy204:
    buffer_load_dwordx4 v[116:119], v3, s[44:47], s57 offen nt
    s_addk_i32 s57, 4096
    s_waitcnt lgkmcnt(0)
    s_lshl_b32 s9, s76, 4
    s_sub_u32 s8, s9, s74
    s_cmp_gt_i32 s8, s66
    s_cselect_b64 vcc, -1, 0
    s_cmpk_lt_i32 s8, -160
    s_cselect_b32 s78, 1, 0
    s_add_u32 s74, s74, s68
    s_waitcnt vmcnt(6)
    s_cbranch_vccnz L_dy205
    s_cmp_eq_u32 s78, 0
    s_cbranch_scc1 L_dy205n
    s_waitcnt vmcnt(3)
L_dy205n:
    s_waitcnt vmcnt(4)
L_dy205:
    buffer_load_dwordx4 v[120:123], v3, s[44:47], s57 offen nt
    s_addk_i32 s57, 4096
    s_memrealtime s[76:77]
    v_perm_b32 v40, v92, v88, s60
    v_perm_b32 v41, v92, v88, s61
    v_dot2c_f32_bf16 v24, v40, v37
    v_dot2c_f32_bf16 v25, v41, v37
    v_perm_b32 v42, v93, v89, s60
    v_perm_b32 v43, v93, v89, s61
    v_dot2c_f32_bf16 v26, v42, v37
    v_dot2c_f32_bf16 v27, v43, v37
    v_perm_b32 v40, v94, v90, s60
    v_perm_b32 v41, v94, v90, s61
    v_dot2c_f32_bf16 v28, v40, v37
    v_dot2c_f32_bf16 v29, v41, v37
    v_perm_b32 v42, v95, v91, s60
    v_perm_b32 v43, v95, v91, s61
    v_dot2c_f32_bf16 v30, v42, v37
    v_dot2c_f32_bf16 v31, v43, v37
    s_waitcnt vmcnt(6)
    s_cbranch_vccnz L_dy206
    s_cmp_eq_u32 s78, 0
    s_cbranch_scc1 L_dy206n
    s_waitcnt vmcnt(3)
L_dy206n:
    s_waitcnt vmcnt(4)
L_dy206:
    buffer_load_dwordx4 v[124:127], v3, s[44:47], s57 offen nt
    s_add_u32 s57, s57, 0xd000
    s_and_b32 s57, s57, s63
    s_waitcnt lgkmcnt(0)
    s_lshl_b32 s9, s76, 4
    s_sub_u32 s8, s9, s74
    s_cmp_gt_i32 s8, s66
    s_cselect_b64 vcc, -1, 0
    s_cmpk_lt_i32 s8, -160
    s_cselect_b32 s78, 1, 0
    s_add_u32 s74, s74, s68
    s_waitcnt vmcnt(6)
    s_cbranch_vccnz L_dy207
    s_cmp_eq_u32 s78, 0
    s_cbranch_scc1 L_dy207n
    s_waitcnt vmcnt(3)
L_dy207n:
    s_waitcnt vmcnt(4)
L_dy207:
    buffer_load_dwordx4 v[128:131], v3, s[44:47], s57 offen nt
    s_addk_i32 s57, 4096
    s_memrealtime s[76:77]
    v_perm_b32 v40, v100, v96, s60
    v_perm_b32 v41, v100, v96, s61
    v_dot2c_f32_bf16 v24, v40, v38
    v_dot2c_f32_bf16 v25, v41, v38
    v_perm_b32 v42, v101, v97, s60
    v_perm_b32 v43, v101, v97, s61
    v_dot2c_f32_bf16 v26, v42, v38
    v_dot2c_f32_bf16 v27, v43, v38
    v_perm_b32 v40, v102, v98, s60
    v_perm_b32 v41, v102, v98, s61
    v_dot2c_f32_bf16 v28, v40, v38
    v_dot2c_f32_bf16 v29, v41, v38
    v_perm_b32 v42, v103, v99, s60
    v_perm_b32 v43, v103, v99, s61
    v_dot2c_f32_bf16 v30, v42, v38
    v_dot2c_f32_bf16 v31, v43, v38
    s_waitcnt vmcnt(6)
    s_cbranch_vccnz L_dy208
    s_cmp_eq_u32 s78, 0
    s_cbranch_scc1 L_dy208n
    s_waitcnt vmcnt(3)
L_dy208n:
    s_waitcnt vmcnt(4)
L_dy208:
    buffer_load_dwordx4 v[132:135], v3, s[44:47], s57 offen nt
    s_addk_i32 s57, 4096
    s_waitcnt lgkmcnt(0)
    s_lshl_b32 s9, s76, 4
    s_sub_u32 s8, s9, s74
    s_cmp_gt_i32 s8, s66
    s_cselect_b64 vcc, -1, 0
    s_cmpk_lt_i32 s8, -160
    s_cselect_b32 s78, 1, 0
    s_add_u32 s74, s74, s68
    s_waitcnt vmcnt(6)
    s_cbranch_vccnz L_dy209
    s_cmp_eq_u32 s78, 0
    s_cbranch_scc1 L_dy209n
    s_waitcnt vmcnt(3)
L_dy209n:
    s_waitcnt vmcnt(4)
L_dy209:
    buffer_load_dwordx4 v[136:139], v3, s[44:47], s57 offen nt
    s_addk_i32 s57, 4096
    s_memrealtime s[76:77]
    v_perm_b32 v40, v108, v104, s60
    v_perm_b32 v41, v108, v104, s61
    v_dot2c_f32_bf16 v24, v40, v39
    v_dot2c_f32_bf16 v25, v41, v39
    v_perm_b32 v42, v109, v105, s60
    v_perm_b32 v43, v109, v105, s61
    v_dot2c_f32_bf16 v26, v42, v39
    v_dot2c_f32_bf16 v27, v43, v39
    v_perm_b32 v40, v110, v106, s60
    v_perm_b32 v41, v110, v106, s61
    v_dot2c_f32_bf16 v28, v40, v39
    v_dot2c_f32_bf16 v29, v41, v39
    v_perm_b32 v42, v111, v107, s60
    v_perm_b32 v43, v111, v107, s61
    v_dot2c_f32_bf16 v30, v42, v39
    v_dot2c_f32_bf16 v31, v43, v39
    s_waitcnt vmcnt(6)
    s_cbranch_vccnz L_dy210
    s_cmp_eq_u32 s78, 0
    s_cbranch_scc1 L_dy210n
    s_waitcnt vmcnt(3)
L_dy210n:
    s_waitcnt vmcnt(4)
L_dy210:
    buffer_load_dwordx4 v[140:143], v3, s[44:47], s57 offen nt
    s_add_u32 s57, s57, 0xd000
    s_and_b32 s57, s57, s63
    s_waitcnt lgkmcnt(0)
    s_lshl_b32 s9, s76, 4
    s_sub_u32 s8, s9, s74
    s_cmp_gt_i32 s8, s66
    s_cselect_b64 vcc, -1, 0
    s_cmpk_lt_i32 s8, -160
    s_cselect_b32 s78, 1, 0
    s_add_u32 s74, s74, s68
    s_waitcnt vmcnt(6)
    s_cbranch_vccnz L_dy211
    s_cmp_eq_u32 s78, 0
    s_cbranch_scc1 L_dy211n
    s_waitcnt vmcnt(3)
L_dy211n:
    s_waitcnt vmcnt(4)
L_dy211:
    buffer_load_dwordx4 v[144:147], v3, s[44:47], s57 offen nt
    s_addk_i32 s57, 4096
    s_memrealtime s[76:77]
    s_waitcnt lgkmcnt(0)
    ds_read_b128 v[36:39], v5 offset:208
    v_perm_b32 v40, v116, v112, s60
    v_perm_b32 v41, v116, v112, s61
    v_dot2c_f32_bf16 v24, v40, v32
    v_dot2c_f32_bf16 v25, v41, v32
    v_perm_b32 v42, v117, v113, s60
    v_perm_b32 v43, v117, v113, s61
    v_dot2c_f32_bf16 v26, v42, v32
    v_dot2c_f32_bf16 v27, v43, v32
    v_perm_b32 v40, v118, v114, s60
    v_perm_b32 v41, v118, v114, s61
    v_dot2c_f32_bf16 v28, v40, v32
    v_dot2c_f32_bf16 v29, v41, v32
    v_perm_b32 v42, v119, v115, s60
    v_perm_b32 v43, v119, v115, s61
    v_dot2c_f32_bf16 v30, v42, v32
    v_dot2c_f32_bf16 v31, v43, v32
    s_waitcnt vmcnt(6)
    s_cbranch_vccnz L_dy212
    s_cmp_eq_u32 s78, 0
    s_cbranch_scc1 L_dy212n
    s_waitcnt vmcnt(3)
L_dy212n:
    s_waitcnt vmcnt(4)
L_dy212:
    buffer_load_dwordx4 v[148:151], v3, s[44:47], s57 offen nt
    s_addk_i32 s57, 4096
    s_waitcnt lgkmcnt(0)
    s_lshl_b32 s9, s76, 4
    s_sub_u32 s8, s9, s74
    s_cmp_gt_i32 s8, s66
    s_cselect_b64 vcc, -1, 0
    s_cmpk_lt_i32 s8, -160
    s_cselect_b32 s78, 1, 0
    s_add_u32 s74, s74, s68
    s_waitcnt vmcnt(6)
    s_cbranch_vccnz L_dy213
    s_cmp_eq_u32 s78, 0
    s_cbranch_scc1 L_dy213n
    s_waitcnt vmcnt(3)
L_dy213n:
    s_waitcnt vmcnt(4)
L_dy213:
    buffer_load_dwordx4 v[152:155], v3, s[44:47], s57 offen nt
    s_addk_i32 s57, 4096
    s_memrealtime s[76:77]
    v_perm_b32 v40, v124, v120, s60
    v_perm_b32 v41, v124, v120, s61
    v_dot2c_f32_bf16 v24, v40, v33
    v_dot2c_f32_bf16 v25, v41, v33
    v_perm_b32 v42, v125, v121, s60
    v_perm_b32 v43, v125, v121, s61
    v_dot2c_f32_bf16 v26, v42, v33
    v_dot2c_f32_bf16 v27, v43, v33
    v_perm_b32 v40, v126, v122, s60
    v_perm_b32 v41, v126, v122, s61
    v_dot2c_f32_bf16 v28, v40, v33
    v_dot2c_f32_bf16 v29, v41, v33
    v_perm_b32 v42, v127, v123, s60
    v_perm_b32 v43, v127, v123, s61
    v_dot2c_f32_bf16 v30, v42, v33
    v_dot2c_f32_bf16 v31, v43, v33
    s_waitcnt vmcnt(6)
    s_cbranch_vccnz L_dy214
    s_cmp_eq_u32 s78, 0
    s_cbranch_scc1 L_dy214n
    s_waitcnt vmcnt(3)
L_dy214n:
    s_waitcnt vmcnt(4)
L_dy214:
    buffer_load_dwordx4 v[156:159], v3, s[44:47], s57 offen nt
    s_add_u32 s57, s57, 0xd000
    s_and_b32 s57, s57, s63
    s_waitcnt lgkmcnt(0)
    s_lshl_b32 s9, s76, 4
    s_sub_u32 s8, s9, s74
    s_cmp_gt_i32 s8, s66
    s_cselect_b64 vcc, -1, 0
    s_cmpk_lt_i32 s8, -160
    s_cselect_b32 s78, 1, 0
    s_add_u32 s74, s74, s68
    s_waitcnt vmcnt(6)
    s_cbranch_vccnz L_dy215
    s_cmp_eq_u32 s78, 0
    s_cbranch_scc1 L_dy215n
    s_waitcnt vmcnt(3)
L_dy215n:
    s_waitcnt vmcnt(4)
L_dy215:
    buffer_load_dwordx4 v[160:163], v3, s[44:47], s57 offen nt
    s_addk_i32 s57, 4096
    s_memrealtime s[76:77]
    v_perm_b32 v40, v132, v128, s60
    v_perm_b32 v41, v132, v128, s61
    v_dot2c_f32_bf16 v24, v40, v34
    v_dot2c_f32_bf16 v25, v41, v34
    v_perm_b32 v42, v133, v129, s60
    v_perm_b32 v43, v133, v129, s61
    v_dot2c_f32_bf16 v26, v42, v34
    v_dot2c_f32_bf16 v27, v43, v34
    v_perm_b32 v40, v134, v130, s60
    v_perm_b32 v41, v134, v130, s61
    v_dot2c_f32_bf16 v28, v40, v34
    v_dot2c_f32_bf16 v29, v41, v34
    v_perm_b32 v42, v135, v131, s60
    v_perm_b32 v43, v135, v131, s61
    v_dot2c_f32_bf16 v30, v42, v34
    v_dot2c_f32_bf16 v31, v43, v34
    s_waitcnt vmcnt(6)
    s_cbranch_vccnz L_dy216
    s_cmp_eq_u32 s78, 0
    s_cbranch_scc1 L_dy216n
    s_waitcnt vmcnt(3)
L_dy216n:
    s_waitcnt vmcnt(4)
L_dy216:
    buffer_load_dwordx4 v[164:167], v3, s[44:47], s57 offen nt
    s_addk_i32 s57, 4096
    s_waitcnt lgkmcnt(0)
    s_lshl_b32 s9, s76, 4
    s_sub_u32 s8, s9, s74
    s_cmp_gt_i32 s8, s66
    s_cselect_b64 vcc, -1, 0
    s_cmpk_lt_i32 s8, -160
    s_cselect_b32 s78, 1, 0
    s_add_u32 s74, s74, s68
    s_waitcnt vmcnt(6)
    s_cbranch_vccnz L_dy217
    s_cmp_eq_u32 s78, 0
    s_cbranch_scc1 L_dy217n
    s_waitcnt vmcnt(3)
L_dy217n:
    s_waitcnt vmcnt(4)
L_dy217:
    buffer_load_dwordx4 v[168:171], v3, s[44:47], s57 offen nt
    s_addk_i32 s57, 4096
    s_memrealtime s[76:77]
    v_perm_b32 v40, v140, v136, s60
    v_perm_b32 v41, v140, v136, s61
    v_dot2c_f32_bf16 v24, v40, v35
    v_dot2c_f32_bf16 v25, v41, v35
    v_perm_b32 v42, v141, v137, s60
    v_perm_b32 v43, v141, v137, s61
    v_dot2c_f32_bf16 v26, v42, v35
    v_dot2c_f32_bf16 v27, v43, v35
    v_perm_b32 v40, v142, v138, s60
    v_perm_b32 v41, v142, v138, s61
    v_dot2c_f32_bf16 v28, v40, v35
    v_dot2c_f32_bf16 v29, v41, v35
    v_perm_b32 v42, v143, v139, s60
    v_perm_b32 v43, v143, v139, s61
    v_dot2c_f32_bf16 v30, v42, v35
    v_dot2c_f32_bf16 v31, v43, v35
    s_waitcnt vmcnt(6)
    s_cbranch_vccnz L_dy218
    s_cmp_eq_u32 s78, 0
    s_cbranch_scc1 L_dy218n
    s_waitcnt vmcnt(3)
L_dy218n:
    s_waitcnt vmcnt(4)
L_dy218:
    buffer_load_dwordx4 v[172:175], v3, s[44:47], s57 offen nt
    s_add_u32 s57, s57, 0xd000
    s_and_b32 s57, s57, s63
    s_waitcnt lgkmcnt(0)
    s_lshl_b32 s9, s76, 4
    s_sub_u32 s8, s9, s74
    s_cmp_gt_i32 s8, s66
    s_cselect_b64 vcc, -1, 0
    s_cmpk_lt_i32 s8, -160
    s_cselect_b32 s78, 1, 0
    s_add_u32 s74, s74, s68
    s_waitcnt vmcnt(6)
    s_cbranch_vccnz L_dy219
    s_cmp_eq_u32 s78, 0
    s_cbranch_scc1 L_dy219n
    s_waitcnt vmcnt(3)
L_dy219n:
    s_waitcnt vmcnt(4)
L_dy219:
    buffer_load_dwordx4 v[176:179], v3, s[44:47], s57 offen nt
    s_addk_i32 s57, 4096
    s_memrealtime s[76:77]
    s_waitcnt lgkmcnt(0)
    ds_read_b128 v[32:35], v5 offset:224
    v_perm_b32 v40, v148, v144, s60
    v_perm_b32 v41, v148, v144, s61
    v_dot2c_f32_bf16 v24, v40, v36
    v_dot2c_f32_bf16 v25, v41, v36
    v_perm_b32 v42, v149, v145, s60
    v_perm_b32 v43, v149, v145, s61
    v_dot2c_f32_bf16 v26, v42, v36
    v_dot2c_f32_bf16 v27, v43, v36
    v_perm_b32 v40, v150, v146, s60
    v_perm_b32 v41, v150, v146, s61
    v_dot2c_f32_bf16 v28, v40, v36
    v_dot2c_f32_bf16 v29, v41, v36
    v_perm_b32 v42, v151, v147, s60
    v_perm_b32 v43, v151, v147, s61
    v_dot2c_f32_bf16 v30, v42, v36
    v_dot2c_f32_bf16 v31, v43, v36
    s_waitcnt vmcnt(6)
    s_cbranch_vccnz L_dy220
    s_cmp_eq_u32 s78, 0
    s_cbranch_scc1 L_dy220n
    s_waitcnt vmcnt(3)
L_dy220n:
    s_waitcnt vmcnt(4)
L_dy220:
    buffer_load_dwordx4 v[180:183], v3, s[44:47], s57 offen nt
    s_addk_i32 s57, 4096
    s_waitcnt lgkmcnt(0)
    s_lshl_b32 s9, s76, 4
    s_sub_u32 s8, s9, s74
    s_cmp_gt_i32 s8, s66
    s_cselect_b64 vcc, -1, 0
    s_cmpk_lt_i32 s8, -160
    s_cselect_b32 s78, 1, 0
    s_add_u32 s74, s74, s68
    s_waitcnt vmcnt(6)
    s_cbranch_vccnz L_dy221
    s_cmp_eq_u32 s78, 0
    s_cbranch_scc1 L_dy221n
    s_waitcnt vmcnt(3)
L_dy221n:
    s_waitcnt vmcnt(4)
L_dy221:
    buffer_load_dwordx4 v[184:187], v3, s[44:47], s57 offen nt
    s_addk_i32 s57, 4096
    s_memrealtime s[76:77]
    v_perm_b32 v40, v156, v152, s60
    v_perm_b32 v41, v156, v152, s61
    v_dot2c_f32_bf16 v24, v40, v37
    v_dot2c_f32_bf16 v25, v41, v37
    v_perm_b32 v42, v157, v153, s60
    v_perm_b32 v43, v157, v153, s61
    v_dot2c_f32_bf16 v26, v42, v37
    v_dot2c_f32_bf16 v27, v43, v37
    v_perm_b32 v40, v158, v154, s60
    v_perm_b32 v41, v158, v154, s61
    v_dot2c_f32_bf16 v28, v40, v37
    v_dot2c_f32_bf16 v29, v41, v37
    v_perm_b32 v42, v159, v155, s60
    v_perm_b32 v43, v159, v155, s61
    v_dot2c_f32_bf16 v30, v42, v37
    v_dot2c_f32_bf16 v31, v43, v37
    s_waitcnt vmcnt(6)
    s_cbranch_vccnz L_dy222
    s_cmp_eq_u32 s78, 0
    s_cbranch_scc1 L_dy222n
    s_waitcnt vmcnt(3)
L_dy222n:
    s_waitcnt vmcnt(4)
L_dy222:
    buffer_load_dwordx4 v[188:191], v3, s[44:47], s57 offen nt
    s_add_u32 s57, s57, 0xd000
    s_and_b32 s57, s57, s63
    s_waitcnt lgkmcnt(0)
    s_lshl_b32 s9, s76, 4
    s_sub_u32 s8, s9, s74
    s_cmp_gt_i32 s8, s66
    s_cselect_b64 vcc, -1, 0
    s_cmpk_lt_i32 s8, -160
    s_cselect_b32 s78, 1, 0
    s_add_u32 s74, s74, s68
    s_waitcnt vmcnt(6)
    s_cbranch_vccnz L_dy223
    s_cmp_eq_u32 s78, 0
    s_cbranch_scc1 L_dy223n
    s_waitcnt vmcnt(3)
L_dy223n:
    s_waitcnt vmcnt(4)
L_dy223:
    buffer_load_dwordx4 v[192:195], v3, s[44:47], s57 offen nt
    s_addk_i32 s57, 4096
    s_memrealtime s[76:77]
    v_perm_b32 v40, v164, v160, s60
    v_perm_b32 v41, v164, v160, s61
    v_dot2c_f32_bf16 v24, v40, v38
    v_dot2c_f32_bf16 v25, v41, v38
    v_perm_b32 v42, v165, v161, s60
    v_perm_b32 v43, v165, v161, s61
    v_dot2c_f32_bf16 v26, v42, v38
    v_dot2c_f32_bf16 v27, v43, v38
    v_perm_b32 v40, v166, v162, s60
    v_perm_b32 v41, v166, v162, s61
    v_dot2c_f32_bf16 v28, v40, v38
    v_dot2c_f32_bf16 v29, v41, v38
    v_perm_b32 v42, v167, v163, s60
    v_perm_b32 v43, v167, v163, s61
    v_dot2c_f32_bf16 v30, v42, v38
    v_dot2c_f32_bf16 v31, v43, v38
    s_waitcnt vmcnt(6)
    s_cbranch_vccnz L_dy224
    s_cmp_eq_u32 s78, 0
    s_cbranch_scc1 L_dy224n
    s_waitcnt vmcnt(3)
L_dy224n:
    s_waitcnt vmcnt(4)
L_dy224:
    buffer_load_dwordx4 v[196:199], v3, s[44:47], s57 offen nt
    s_addk_i32 s57, 4096
    s_waitcnt lgkmcnt(0)
    s_lshl_b32 s9, s76, 4
    s_sub_u32 s8, s9, s74
    s_cmp_gt_i32 s8, s66
    s_cselect_b64 vcc, -1, 0
    s_cmpk_lt_i32 s8, -160
    s_cselect_b32 s78, 1, 0
    s_add_u32 s74, s74, s68
    s_waitcnt vmcnt(6)
    s_cbranch_vccnz L_dy225
    s_cmp_eq_u32 s78, 0
    s_cbranch_scc1 L_dy225n
    s_waitcnt vmcnt(3)
L_dy225n:
    s_waitcnt vmcnt(4)
L_dy225:
    buffer_load_dwordx4 v[200:203], v3, s[44:47], s57 offen nt
    s_addk_i32 s57, 4096
    s_memrealtime s[76:77]
    v_perm_b32 v40, v172, v168, s60
    v_perm_b32 v41, v172, v168, s61
    v_dot2c_f32_bf16 v24, v40, v39
    v_dot2c_f32_bf16 v25, v41, v39
    v_perm_b32 v42, v173, v169, s60
    v_perm_b32 v43, v173, v169, s61
    v_dot2c_f32_bf16 v26, v42, v39
    v_dot2c_f32_bf16 v27, v43, v39
    v_perm_b32 v40, v174, v170, s60
    v_perm_b32 v41, v174, v170, s61
    v_dot2c_f32_bf16 v28, v40, v39
    v_dot2c_f32_bf16 v29, v41, v39
    v_perm_b32 v42, v175, v171, s60
    v_perm_b32 v43, v175, v171, s61
    v_dot2c_f32_bf16 v30, v42, v39
    v_dot2c_f32_bf16 v31, v43, v39
    s_waitcnt vmcnt(6)
    s_cbranch_vccnz L_dy226
    s_cmp_eq_u32 s78, 0
    s_cbranch_scc1 L_dy226n
    s_waitcnt vmcnt(3)
L_dy226n:
    s_waitcnt vmcnt(4)
L_dy226:
    buffer_load_dwordx4 v[204:207], v3, s[44:47], s57 offen nt
    s_add_u32 s57, s57, 0xd000
    s_and_b32 s57, s57, s63
    s_waitcnt lgkmcnt(0)
    s_lshl_b32 s9, s76, 4
    s_sub_u32 s8, s9, s74
    s_cmp_gt_i32 s8, s66
    s_cselect_b64 vcc, -1, 0
    s_cmpk_lt_i32 s8, -160
    s_cselect_b32 s78, 1, 0
    s_add_u32 s74, s74, s68
    s_waitcnt vmcnt(6)
    s_cbranch_vccnz L_dy227
    s_cmp_eq_u32 s78, 0
    s_cbranch_scc1 L_dy227n
    s_waitcnt vmcnt(3)
L_dy227n:
    s_waitcnt vmcnt(4)
L_dy227:
    buffer_load_dwordx4 v[208:211], v3, s[44:47], s57 offen nt
    s_addk_i32 s57, 4096
    s_memrealtime s[76:77]
    s_waitcnt lgkmcnt(0)
    ds_read_b128 v[36:39], v5 offset:240
    v_perm_b32 v40, v180, v176, s60
    v_perm_b32 v41, v180, v176, s61
    v_dot2c_f32_bf16 v24, v40, v32
    v_dot2c_f32_bf16 v25, v41, v32
    v_perm_b32 v42, v181, v177, s60
    v_perm_b32 v43, v181, v177, s61
    v_dot2c_f32_bf16 v26, v42, v32
    v_dot2c_f32_bf16 v27, v43, v32
    v_perm_b32 v40, v182, v178, s60
    v_perm_b32 v41, v182, v178, s61
    v_dot2c_f32_bf16 v28, v40, v32
    v_dot2c_f32_bf16 v29, v41, v32
    v_perm_b32 v42, v183, v179, s60
    v_perm_b32 v43, v183, v179, s61
    v_dot2c_f32_bf16 v30, v42, v32
    v_dot2c_f32_bf16 v31, v43, v32
    s_waitcnt vmcnt(6)
    s_cbranch_vccnz L_dy228
    s_cmp_eq_u32 s78, 0
    s_cbranch_scc1 L_dy228n
    s_waitcnt vmcnt(3)
L_dy228n:
    s_waitcnt vmcnt(4)
L_dy228:
    buffer_load_dwordx4 v[212:215], v3, s[44:47], s57 offen nt
    s_addk_i32 s57, 4096
    s_waitcnt lgkmcnt(0)
    s_lshl_b32 s9, s76, 4
    s_sub_u32 s8, s9, s74
    s_cmp_gt_i32 s8, s66
    s_cselect_b64 vcc, -1, 0
    s_cmpk_lt_i32 s8, -160
    s_cselect_b32 s78, 1, 0
    s_add_u32 s74, s74, s68
    s_waitcnt vmcnt(6)
    s_cbranch_vccnz L_dy229
    s_cmp_eq_u32 s78, 0
    s_cbranch_scc1 L_dy229n
    s_waitcnt vmcnt(3)
L_dy229n:
    s_waitcnt vmcnt(4)
L_dy229:
    buffer_load_dwordx4 v[216:219], v3, s[44:47], s57 offen nt
    s_addk_i32 s57, 4096
    s_memrealtime s[76:77]
    v_perm_b32 v40, v188, v184, s60
    v_perm_b32 v41, v188, v184, s61
    v_dot2c_f32_bf16 v24, v40, v33
    v_dot2c_f32_bf16 v25, v41, v33
    v_perm_b32 v42, v189, v185, s60
    v_perm_b32 v43, v189, v185, s61
    v_dot2c_f32_bf16 v26, v42, v33
    v_dot2c_f32_bf16 v27, v43, v33
    v_perm_b32 v40, v190, v186, s60
    v_perm_b32 v41, v190, v186, s61
    v_dot2c_f32_bf16 v28, v40, v33
    v_dot2c_f32_bf16 v29, v41, v33
    v_perm_b32 v42, v191, v187, s60
    v_perm_b32 v43, v191, v187, s61
    v_dot2c_f32_bf16 v30, v42, v33
    v_dot2c_f32_bf16 v31, v43, v33
    s_waitcnt vmcnt(6)
    s_cbranch_vccnz L_dy230
    s_cmp_eq_u32 s78, 0
    s_cbranch_scc1 L_dy230n
    s_waitcnt vmcnt(3)
L_dy230n:
    s_waitcnt vmcnt(4)
L_dy230:
    buffer_load_dwordx4 v[220:223], v3, s[44:47], s57 offen nt
    s_add_u32 s57, s57, 0xd000
    s_and_b32 s57, s57, s63
    s_waitcnt lgkmcnt(0)
    s_lshl_b32 s9, s76, 4
    s_sub_u32 s8, s9, s74
    s_cmp_gt_i32 s8, s66
    s_cselect_b64 vcc, -1, 0
    v_mov_b32 v47, s74
    ds_write_b32 v22, v47 offset:48
    s_cmpk_lt_i32 s8, -160
    s_cselect_b32 s78, 1, 0
    s_add_u32 s74, s74, s68
    s_waitcnt vmcnt(6)
    s_cbranch_vccnz L_dy231
    s_cmp_eq_u32 s78, 0
    s_cbranch_scc1 L_dy231n
    s_waitcnt vmcnt(3)
L_dy231n:
    s_waitcnt vmcnt(4)
L_dy231:
    buffer_load_dwordx4 v[224:227], v3, s[44:47], s57 offen nt
    s_addk_i32 s57, 4096
    s_memrealtime s[76:77]
    v_perm_b32 v40, v196, v192, s60
    v_perm_b32 v41, v196, v192, s61
    v_dot2c_f32_bf16 v24, v40, v34
    v_dot2c_f32_bf16 v25, v41, v34
    v_perm_b32 v42, v197, v193, s60
    v_perm_b32 v43, v197, v193, s61
    v_dot2c_f32_bf16 v26, v42, v34
    v_dot2c_f32_bf16 v27, v43, v34
    v_perm_b32 v40, v198, v194, s60
    v_perm_b32 v41, v198, v194, s61
    v_dot2c_f32_bf16 v28, v40, v34
    v_dot2c_f32_bf16 v29, v41, v34
    v_perm_b32 v42, v199, v195, s60
    v_perm_b32 v43, v199, v195, s61
    v_dot2c_f32_bf16 v30, v42, v34
    v_dot2c_f32_bf16 v31, v43, v34
    buffer_load_dwordx4 v[228:231], v3, s[44:47], s57 offen nt
    s_addk_i32 s57, 4096
    buffer_load_dwordx4 v[232:235], v3, s[44:47], s57 offen nt
    s_addk_i32 s57, 4096
    buffer_load_dwordx4 v[236:239], v3, s[44:47], s57 offen nt
    s_waitcnt vmcnt(8)
    v_perm_b32 v40, v204, v200, s60
    v_perm_b32 v41, v204, v200, s61
    v_dot2c_f32_bf16 v24, v40, v35
    v_dot2c_f32_bf16 v25, v41, v35
    v_perm_b32 v42, v205, v201, s60
    v_perm_b32 v43, v205, v201, s61
    v_dot2c_f32_bf16 v26, v42, v35
    v_dot2c_f32_bf16 v27, v43, v35
    v_perm_b32 v40, v206, v202, s60
    v_perm_b32 v41, v206, v202, s61
    v_dot2c_f32_bf16 v28, v40, v35
    v_dot2c_f32_bf16 v29, v41, v35
    v_perm_b32 v42, v207, v203, s60
    v_perm_b32 v43, v207, v203, s61
    v_dot2c_f32_bf16 v30, v42, v35
    v_dot2c_f32_bf16 v31, v43, v35
    s_waitcnt lgkmcnt(0)
    s_waitcnt vmcnt(6)
    v_perm_b32 v40, v212, v208, s60
    v_perm_b32 v41, v212, v208, s61
    v_dot2c_f32_bf16 v24, v40, v36
    v_dot2c_f32_bf16 v25, v41, v36
    v_perm_b32 v42, v213, v209, s60
    v_perm_b32 v43, v213, v209, s61
    v_dot2c_f32_bf16 v26, v42, v36
    v_dot2c_f32_bf16 v27, v43, v36
    v_perm_b32 v40, v214, v210, s60
    v_perm_b32 v41, v214, v210, s61
    v_dot2c_f32_bf16 v28, v40, v36
    v_dot2c_f32_bf16 v29, v41, v36
    v_perm_b32 v42, v215, v211, s60
    v_perm_b32 v43, v215, v211, s61
    v_dot2c_f32_bf16 v30, v42, v36
    v_dot2c_f32_bf16 v31, v43, v36
    s_waitcnt vmcnt(4)
    v_perm_b32 v40, v220, v216, s60
    v_perm_b32 v41, v220, v216, s61
    v_dot2c_f32_bf16 v24, v40, v37
    v_dot2c_f32_bf16 v25, v41, v37
    v_perm_b32 v42, v221, v217, s60
    v_perm_b32 v43, v221, v217, s61
    v_dot2c_f32_bf16 v26, v42, v37
    v_dot2c_f32_bf16 v27, v43, v37
    v_perm_b32 v40, v222, v218, s60
    v_perm_b32 v41, v222, v218, s61
    v_dot2c_f32_bf16 v28, v40, v37
    v_dot2c_f32_bf16 v29, v41, v37
    v_perm_b32 v42, v223, v219, s60
    v_perm_b32 v43, v223, v219, s61
    v_dot2c_f32_bf16 v30, v42, v37
    v_dot2c_f32_bf16 v31, v43, v37
    s_waitcnt vmcnt(2)
    v_perm_b32 v40, v228, v224, s60
    v_perm_b32 v41, v228, v224, s61
    v_dot2c_f32_bf16 v24, v40, v38
    v_dot2c_f32_bf16 v25, v41, v38
    v_perm_b32 v42, v229, v225, s60
    v_perm_b32 v43, v229, v225, s61
    v_dot2c_f32_bf16 v26, v42, v38
    v_dot2c_f32_bf16 v27, v43, v38
    v_perm_b32 v40, v230, v226, s60
    v_perm_b32 v41, v230, v226, s61
    v_dot2c_f32_bf16 v28, v40, v38
    v_dot2c_f32_bf16 v29, v41, v38
    v_perm_b32 v42, v231, v227, s60
    v_perm_b32 v43, v231, v227, s61
    v_dot2c_f32_bf16 v30, v42, v38
    v_dot2c_f32_bf16 v31, v43, v38
    s_waitcnt vmcnt(0)
    v_perm_b32 v40, v236, v232, s60
    v_perm_b32 v41, v236, v232, s61
    v_dot2c_f32_bf16 v24, v40, v39
    v_dot2c_f32_bf16 v25, v41, v39
    v_perm_b32 v42, v237, v233, s60
    v_perm_b32 v43, v237, v233, s61
    v_dot2c_f32_bf16 v26, v42, v39
    v_dot2c_f32_bf16 v27, v43, v39
    v_perm_b32 v40, v238, v234, s60
    v_perm_b32 v41, v238, v234, s61
    v_dot2c_f32_bf16 v28, v40, v39
    v_dot2c_f32_bf16 v29, v41, v39
    v_perm_b32 v42, v239, v235, s60
    v_perm_b32 v43, v239, v235, s61
    v_dot2c_f32_bf16 v30, v42, v39
    v_dot2c_f32_bf16 v31, v43, v39
    v_permlane32_swap_b32 v24, v25
    v_permlane32_swap_b32 v26, v27
    v_permlane32_swap_b32 v28, v29
    v_permlane32_swap_b32 v30, v31
    v_add_f32 v24, v24, v25
    v_add_f32 v26, v26, v27
    v_add_f32 v28, v28, v29
    v_add_f32 v30, v30, v31
    v_permlane16_swap_b32 v24, v26
    s_nop 0
    v_permlane16_swap_b32 v28, v30
    v_add_f32 v24, v24, v26
    v_add_f32 v28, v28, v30
    s_nop 0
    v_add_f32_dpp v25, v24, v24 row_ror:8 row_mask:0xf bank_mask:0x3
    s_nop 1
    v_add_f32_dpp v25, v28, v28 row_ror:8 row_mask:0xf bank_mask:0xc
    ds_write_b32 v20, v25
    s_waitcnt lgkmcnt(0)
    s_barrier
    s_endpgm
L_qslow:
    s_mov_b32 s9, 0
L_qslow1:
    s_sleep 1
    ds_read_b32 v46, v22 offset:8
    ds_read_b128 v[8:11], v21 offset:0
    s_waitcnt lgkmcnt(0)
    v_readfirstlane_b32 s8, v46
    s_nop 0
    s_cmp_lg_u32 s8, 0
    s_cbranch_scc1 L_qback
    s_add_u32 s9, s9, 1
    s_cmp_lt_u32 s9, 1600000
    s_cbranch_scc1 L_qslow1
    s_branch L_qback
L_pslow:
    s_mov_b32 s9, 0
L_pslow1:
    s_sleep 1
    ds_read_b32 v46, v23 offset:32
    ds_read_b128 v[32:35], v5
    s_waitcnt lgkmcnt(0)
    v_readfirstlane_b32 s8, v46
    s_nop 0
    s_cmp_lg_u32 s8, 0
    s_cbranch_scc1 L_pback
    s_add_u32 s9, s9, 1
    s_cmp_lt_u32 s9, 1600000
    s_cbranch_scc1 L_pslow1
    s_branch L_pback
.p2align 8
L_helper:
    s_sub_u32 s11, s3, 4
    v_lshlrev_b32 v9, 2, v1
    v_mov_b32 v3, 0
    s_mov_b64 exec, 0xffff
    ds_write_b32 v9, v3 offset:512
    s_mov_b64 exec, -1
    v_mov_b32 v2, 512
    v_lshlrev_b32 v4, 4, v1
    v_lshrrev_b32 v5, 4, v1
    v_and_b32 v6, 15, v1
    v_lshrrev_b32 v7, 3, v1
    v_and_b32 v22, 7, v1
    v_lshlrev_b32 v23, 13, v7
    v_lshl_add_u32 v23, v22, 4, v23
    s_mul_i32 s12, s11, 917504
    s_lshl_b32 s9, s5, 9
    s_add_u32 s12, s12, s9
    s_lshl_b32 s9, s101, 7
    s_add_u32 s12, s12, s9
    s_mul_i32 s8, s4, 896
    s_mov_b32 s42, 896
    s_mov_b32 s43, 0x20000
    s_mov_b32 s46, 3670016
    s_mov_b32 s47, 0x20000
    s_waitcnt lgkmcnt(0)
    s_add_u32 s40, s16, s8
    s_addc_u32 s41, s17, 0
    buffer_load_dwordx4 v[8:11], v4, s[40:43], 0 offen
    s_mov_b32 s44, s22
    s_mov_b32 s45, s23
    s_add_u32 s48, s38, 0
    s_addc_u32 s49, s39, 0
    s_load_dwordx2 s[54:55], s[48:49], 0
    s_lshr_b32 s14, s5, 1
    s_lshr_b32 s13, s2, 3
    s_cmp_eq_u32 s11, 0
    s_cbranch_scc1 L_pfe
    s_mov_b32 s94, 1605632
    s_mov_b32 s95, 0x20000
    v_lshrrev_b32 v28, 5, v1
    v_and_b32 v29, 31, v1
    s_cmp_eq_u32 s11, 3
    s_cbranch_scc1 L_pfd
    s_cmp_eq_u32 s14, 7
    s_cbranch_scc1 L_pfe
    s_cmp_eq_u32 s11, 1
    s_cselect_b32 s92, s28, s30
    s_cselect_b32 s93, s29, s31
    v_mul_u32_u24 v28, 3584, v28
    s_mul_i32 s8, s13, 50176
    s_lshl_b32 s9, s14, 9
    s_add_u32 s8, s8, s9
    s_movk_i32 s9, 7168
    s_branch L_pfl
L_pfd:
    s_mov_b32 s92, s32
    s_mov_b32 s93, s33
    v_mul_u32_u24 v28, 896, v28
    s_lshl_b32 s8, s99, 5
    s_add_u32 s8, s8, s13
    s_mul_i32 s8, s8, 12544
    s_and_b32 s14, s14, 1
    s_lshl_b32 s9, s14, 9
    s_add_u32 s8, s8, s9
    s_movk_i32 s9, 1792
    s_cmp_eq_u32 s14, 1
    s_cselect_b32 exec_lo, 0xffffff, -1
    s_mov_b32 exec_hi, exec_lo
L_pfl:
    v_lshl_add_u32 v28, v29, 4, v28
    buffer_load_dwordx4 v[32:35], v28, s[92:95], s8 offen
    s_add_u32 s8, s8, s9
    buffer_load_dwordx4 v[36:39], v28, s[92:95], s8 offen
    s_add_u32 s8, s8, s9
    buffer_load_dwordx4 v[40:43], v28, s[92:95], s8 offen
    s_add_u32 s8, s8, s9
    buffer_load_dwordx4 v[44:47], v28, s[92:95], s8 offen
    s_add_u32 s8, s8, s9
    buffer_load_dwordx4 v[48:51], v28, s[92:95], s8 offen
    s_add_u32 s8, s8, s9
    buffer_load_dwordx4 v[52:55], v28, s[92:95], s8 offen
    s_add_u32 s8, s8, s9
    buffer_load_dwordx4 v[56:59], v28, s[92:95], s8 offen
    s_mov_b64 exec, -1
L_pfe:
    s_barrier
    s_mov_b32 s50, 2097152
    s_mov_b32 s51, 0x20000
    v_mov_b32 v3, 1
    v_and_b32 v13, 1, v6
    v_lshl_add_u32 v21, v5, 1, v13
    v_lshlrev_b32 v21, 1, v21
    s_mul_i32 s8, s11, 1248
    v_add_u32 v21, s8, v21
    v_lshlrev_b32 v20, 8, v5
    v_lshl_add_u32 v20, v22, 5, v20
    v_bfe_u32 v12, v1, 3, 1
    v_lshl_add_u32 v20, v12, 4, v20
    s_lshl_b32 s8, s11, 10
    v_add_u32 v20, s8, v20
    v_mov_b32 v199, 0
    v_mov_b32 v207, 0
    v_mov_b32 v215, 0
    v_mov_b32 v223, 0
    v_mov_b32 v231, 0
    v_mov_b32 v239, 0
    v_mov_b32 v247, 0
    v_mov_b32 v255, 0
    s_mov_b32 s62, 0x3db8aa3b
    s_cmp_eq_u32 s11, 3
    s_cselect_b32 s74, 0x00ff00ff, -1
    s_mov_b32 s75, s74
    s_lshl_b32 s63, s7, 2
    s_add_u32 s63, s63, s6
    s_waitcnt lgkmcnt(0)
    s_mul_i32 s52, s54, 1664525
    s_add_u32 s52, s52, 1013904223
    s_mul_i32 s53, s55, 22695477
    s_add_u32 s53, s53, 1
    s_or_b32 s53, s53, 15
    s_waitcnt vmcnt(0)
    v_lshlrev_b32 v12, 16, v8
    v_and_b32 v13, 0xffff0000, v8
    v_lshlrev_b32 v14, 16, v9
    v_and_b32 v15, 0xffff0000, v9
    v_lshlrev_b32 v16, 16, v10
    v_and_b32 v17, 0xffff0000, v10
    v_lshlrev_b32 v18, 16, v11
    v_and_b32 v19, 0xffff0000, v11
    v_add_f32 v8, v12, v13
    v_add_f32 v9, v14, v15
    v_add_f32 v10, v16, v17
    v_add_f32 v11, v18, v19
    v_add_f32 v8, v8, v9
    v_add_f32 v10, v10, v11
    v_add_f32 v8, v8, v10
    s_nop 1
    v_add_f32_dpp v8, v8, v8 row_ror:8 row_mask:0xf bank_mask:0xf
    s_nop 1
    v_add_f32_dpp v8, v8, v8 row_ror:4 row_mask:0xf bank_mask:0xf
    s_nop 1
    v_add_f32_dpp v8, v8, v8 row_ror:2 row_mask:0xf bank_mask:0xf
    s_nop 1
    v_add_f32_dpp v8, v8, v8 row_ror:1 row_mask:0xf bank_mask:0xf
    v_mov_b32 v9, v8
    s_nop 1
    v_permlane16_swap_b32 v9, v8
    v_add_f32 v8, v8, v9
    v_mov_b32 v9, v8
    s_nop 1
    v_permlane32_swap_b32 v9, v8
    v_add_f32 v8, v8, v9
    v_mul_f32 v8, 0x3b124925, v8
    v_sub_f32 v9, v12, v8
    v_sub_f32 v11, v13, v8
    v_mul_f32 v10, v9, v9
    v_mul_f32 v24, v11, v11
    v_sub_f32 v9, v14, v8
    v_sub_f32 v11, v15, v8
    v_fmac_f32 v10, v9, v9
    v_fmac_f32 v24, v11, v11
    v_sub_f32 v9, v16, v8
    v_sub_f32 v11, v17, v8
    v_fmac_f32 v10, v9, v9
    v_fmac_f32 v24, v11, v11
    v_sub_f32 v9, v18, v8
    v_sub_f32 v11, v19, v8
    v_fmac_f32 v10, v9, v9
    v_fmac_f32 v24, v11, v11
    v_cmp_gt_u32 vcc, 56, v1
    v_add_f32 v10, v10, v24
    s_nop 0
    v_cndmask_b32 v10, 0, v10, vcc
    s_nop 1
    v_add_f32_dpp v10, v10, v10 row_ror:8 row_mask:0xf bank_mask:0xf
    s_nop 1
    v_add_f32_dpp v10, v10, v10 row_ror:4 row_mask:0xf bank_mask:0xf
    s_nop 1
    v_add_f32_dpp v10, v10, v10 row_ror:2 row_mask:0xf bank_mask:0xf
    s_nop 1
    v_add_f32_dpp v10, v10, v10 row_ror:1 row_mask:0xf bank_mask:0xf
    v_mov_b32 v9, v10
    s_nop 1
    v_permlane16_swap_b32 v9, v10
    v_add_f32 v10, v10, v9
    v_mov_b32 v9, v10
    s_nop 1
    v_permlane32_swap_b32 v9, v10
    v_add_f32 v10, v10, v9
    v_mul_f32 v10, 0x3b124925, v10
    v_cvt_pk_bf16_f32 v9, v8, v10
    v_lshlrev_b32 v8, 16, v9
    v_and_b32 v10, 0xffff0000, v9
    v_add_f32 v10, 0x3727c5ac, v10
    v_cvt_pk_bf16_f32 v10, v10, v10
    v_lshlrev_b32 v10, 16, v10
    v_sqrt_f32 v10, v10
    v_sub_f32 v12, v12, v8
    v_sub_f32 v13, v13, v8
    v_sub_f32 v14, v14, v8
    v_sub_f32 v15, v15, v8
    v_sub_f32 v16, v16, v8
    v_sub_f32 v17, v17, v8
    v_sub_f32 v18, v18, v8
    v_sub_f32 v19, v19, v8
    v_cvt_pk_bf16_f32 v10, v10, v10
    v_lshlrev_b32 v10, 16, v10
    v_rcp_f32 v10, v10
    v_cvt_pk_bf16_f32 v24, v12, v13
    v_cvt_pk_bf16_f32 v25, v14, v15
    v_cvt_pk_bf16_f32 v26, v16, v17
    v_cvt_pk_bf16_f32 v27, v18, v19
    v_lshlrev_b32 v12, 16, v24
    v_and_b32 v13, 0xffff0000, v24
    v_lshlrev_b32 v14, 16, v25
    v_and_b32 v15, 0xffff0000, v25
    v_lshlrev_b32 v16, 16, v26
    v_and_b32 v17, 0xffff0000, v26
    v_lshlrev_b32 v18, 16, v27
    v_and_b32 v19, 0xffff0000, v27
    v_mul_f32 v12, v12, v10
    v_mul_f32 v13, v13, v10
    v_mul_f32 v14, v14, v10
    v_mul_f32 v15, v15, v10
    v_mul_f32 v16, v16, v10
    v_mul_f32 v17, v17, v10
    v_mul_f32 v18, v18, v10
    v_mul_f32 v19, v19, v10
    v_cvt_pk_bf16_f32 v24, v12, v13
    v_cvt_pk_bf16_f32 v25, v14, v15
    v_cvt_pk_bf16_f32 v26, v16, v17
    v_cvt_pk_bf16_f32 v27, v18, v19
    s_lshl_b32 s8, s11, 10
    v_add_u32 v9, s8, v4
    ds_write_b128 v9, v[24:27] offset:2048
    ds_read_u16 v32, v21 offset:2048
    ds_read_u16 v33, v21 offset:2064
    ds_read_u16 v34, v21 offset:2080
    ds_read_u16 v35, v21 offset:2096
    ds_read_u16 v36, v21 offset:2112
    ds_read_u16 v37, v21 offset:2128
    ds_read_u16 v38, v21 offset:2144
    ds_read_u16 v39, v21 offset:2160
    ds_read_u16 v40, v21 offset:2176
    ds_read_u16 v41, v21 offset:2192
    ds_read_u16 v42, v21 offset:2208
    ds_read_u16 v43, v21 offset:2224
    ds_read_u16 v44, v21 offset:2240
    ds_read_u16 v45, v21 offset:2256
    buffer_load_dwordx4 v[64:67], v23, s[44:47], s12 offen
    s_add_u32 s12, s12, 65536
    buffer_load_dwordx4 v[68:71], v23, s[44:47], s12 offen
    s_add_u32 s12, s12, 65536
    buffer_load_dwordx4 v[72:75], v23, s[44:47], s12 offen
    s_add_u32 s12, s12, 65536
    buffer_load_dwordx4 v[76:79], v23, s[44:47], s12 offen
    s_add_u32 s12, s12, 65536
    s_waitcnt vmcnt(3)
    buffer_load_dwordx4 v[80:83], v23, s[44:47], s12 offen
    s_add_u32 s12, s12, 65536
    s_waitcnt vmcnt(3)
    buffer_load_dwordx4 v[84:87], v23, s[44:47], s12 offen
    s_add_u32 s12, s12, 65536
    s_waitcnt vmcnt(3)
    buffer_load_dwordx4 v[88:91], v23, s[44:47], s12 offen
    s_add_u32 s12, s12, 65536
    s_waitcnt vmcnt(3)
    buffer_load_dwordx4 v[92:95], v23, s[44:47], s12 offen
    s_add_u32 s12, s12, 65536
    s_waitcnt vmcnt(3)
    buffer_load_dwordx4 v[96:99], v23, s[44:47], s12 offen
    s_add_u32 s12, s12, 65536
    s_waitcnt vmcnt(3)
    buffer_load_dwordx4 v[100:103], v23, s[44:47], s12 offen
    s_add_u32 s12, s12, 65536
    s_waitcnt vmcnt(3)
    buffer_load_dwordx4 v[104:107], v23, s[44:47], s12 offen
    s_add_u32 s12, s12, 65536
    s_waitcnt vmcnt(3)
    buffer_load_dwordx4 v[108:111], v23, s[44:47], s12 offen
    s_add_u32 s12, s12, 65536
    s_waitcnt vmcnt(3)
    buffer_load_dwordx4 v[112:115], v23, s[44:47], s12 offen
    s_add_u32 s12, s12, 65536
    s_waitcnt vmcnt(3)
    buffer_load_dwordx4 v[116:119], v23, s[44:47], s12 offen
    s_waitcnt vmcnt(0)
    v_perm_b32 v192, v68, v64, s60
    v_perm_b32 v193, v76, v72, s60
    v_perm_b32 v194, v84, v80, s60
    v_perm_b32 v195, v92, v88, s60
    v_perm_b32 v196, v100, v96, s60
    v_perm_b32 v197, v108, v104, s60
    v_perm_b32 v198, v116, v112, s60
    v_perm_b32 v200, v68, v64, s61
    v_perm_b32 v201, v76, v72, s61
    v_perm_b32 v202, v84, v80, s61
    v_perm_b32 v203, v92, v88, s61
    v_perm_b32 v204, v100, v96, s61
    v_perm_b32 v205, v108, v104, s61
    v_perm_b32 v206, v116, v112, s61
    v_perm_b32 v208, v69, v65, s60
    v_perm_b32 v209, v77, v73, s60
    v_perm_b32 v210, v85, v81, s60
    v_perm_b32 v211, v93, v89, s60
    v_perm_b32 v212, v101, v97, s60
    v_perm_b32 v213, v109, v105, s60
    v_perm_b32 v214, v117, v113, s60
    v_perm_b32 v216, v69, v65, s61
    v_perm_b32 v217, v77, v73, s61
    v_perm_b32 v218, v85, v81, s61
    v_perm_b32 v219, v93, v89, s61
    v_perm_b32 v220, v101, v97, s61
    v_perm_b32 v221, v109, v105, s61
    v_perm_b32 v222, v117, v113, s61
    v_perm_b32 v224, v70, v66, s60
    v_perm_b32 v225, v78, v74, s60
    v_perm_b32 v226, v86, v82, s60
    v_perm_b32 v227, v94, v90, s60
    v_perm_b32 v228, v102, v98, s60
    v_perm_b32 v229, v110, v106, s60
    v_perm_b32 v230, v118, v114, s60
    v_perm_b32 v232, v70, v66, s61
    v_perm_b32 v233, v78, v74, s61
    v_perm_b32 v234, v86, v82, s61
    v_perm_b32 v235, v94, v90, s61
    v_perm_b32 v236, v102, v98, s61
    v_perm_b32 v237, v110, v106, s61
    v_perm_b32 v238, v118, v114, s61
    v_perm_b32 v240, v71, v67, s60
    v_perm_b32 v241, v79, v75, s60
    v_perm_b32 v242, v87, v83, s60
    v_perm_b32 v243, v95, v91, s60
    v_perm_b32 v244, v103, v99, s60
    v_perm_b32 v245, v111, v107, s60
    v_perm_b32 v246, v119, v115, s60
    v_perm_b32 v248, v71, v67, s61
    v_perm_b32 v249, v79, v75, s61
    v_perm_b32 v250, v87, v83, s61
    v_perm_b32 v251, v95, v91, s61
    v_perm_b32 v252, v103, v99, s61
    v_perm_b32 v253, v111, v107, s61
    v_perm_b32 v254, v119, v115, s61
    s_waitcnt lgkmcnt(0)
    v_lshl_or_b32 v24, v33, 16, v32
    v_lshl_or_b32 v25, v35, 16, v34
    v_lshl_or_b32 v26, v37, 16, v36
    v_lshl_or_b32 v27, v39, 16, v38
    v_lshl_or_b32 v28, v41, 16, v40
    v_lshl_or_b32 v29, v43, 16, v42
    v_lshl_or_b32 v30, v45, 16, v44
    v_mov_b32 v31, 0
    v_mfma_f32_16x16x32_bf16 v[32:35], v[24:27], v[192:195], 0
    v_mfma_f32_16x16x32_bf16 v[36:39], v[24:27], v[200:203], 0
    v_mfma_f32_16x16x32_bf16 v[40:43], v[24:27], v[208:211], 0
    v_mfma_f32_16x16x32_bf16 v[44:47], v[24:27], v[216:219], 0
    v_mfma_f32_16x16x32_bf16 v[48:51], v[24:27], v[224:227], 0
    v_mfma_f32_16x16x32_bf16 v[52:55], v[24:27], v[232:235], 0
    v_mfma_f32_16x16x32_bf16 v[56:59], v[24:27], v[240:243], 0
    v_mfma_f32_16x16x32_bf16 v[60:63], v[24:27], v[248:251], 0
    v_mfma_f32_16x16x32_bf16 v[32:35], v[28:31], v[196:199], v[32:35]
    v_mfma_f32_16x16x32_bf16 v[36:39], v[28:31], v[204:207], v[36:39]
    v_mfma_f32_16x16x32_bf16 v[40:43], v[28:31], v[212:215], v[40:43]
    v_mfma_f32_16x16x32_bf16 v[44:47], v[28:31], v[220:223], v[44:47]
    v_mfma_f32_16x16x32_bf16 v[48:51], v[28:31], v[228:231], v[48:51]
    v_mfma_f32_16x16x32_bf16 v[52:55], v[28:31], v[236:239], v[52:55]
    v_mfma_f32_16x16x32_bf16 v[56:59], v[28:31], v[244:247], v[56:59]
    v_mfma_f32_16x16x32_bf16 v[60:63], v[28:31], v[252:255], v[60:63]
    s_nop 0
    v_add_f32_dpp v12, v33, v32 row_ror:8 row_mask:0xf bank_mask:0x3
    s_nop 2
    v_add_f32_dpp v12, v48, v49 row_ror:8 row_mask:0xf bank_mask:0xc
    v_add_f32_dpp v13, v37, v36 row_ror:8 row_mask:0xf bank_mask:0x3
    s_nop 1
    v_add_f32_dpp v13, v52, v53 row_ror:8 row_mask:0xf bank_mask:0xc
    v_add_f32_dpp v14, v41, v40 row_ror:8 row_mask:0xf bank_mask:0x3
    s_nop 1
    v_add_f32_dpp v14, v56, v57 row_ror:8 row_mask:0xf bank_mask:0xc
    v_add_f32_dpp v15, v45, v44 row_ror:8 row_mask:0xf bank_mask:0x3
    s_nop 1
    v_add_f32_dpp v15, v60, v61 row_ror:8 row_mask:0xf bank_mask:0xc
    ds_write_b128 v20, v[12:15] offset:24576
    s_waitcnt lgkmcnt(0)
    s_mov_b64 exec, 1
    ds_add_u32 v2, v3 offset:0
    s_mov_b64 exec, -1
    s_cmp_lg_u32 s11, 0
    s_cbranch_scc1 L_qdone
    v_mov_b32 v14, s52
    v_mov_b32 v15, s53
    s_getreg_b32 s14, hwreg(HW_REG_XCC_ID, 0, 4)
    s_andn2_b32 s8, s53, 15
    s_or_b32 s14, s14, s8
    v_mov_b32 v15, s14
    s_lshl_b32 s12, s7, 10
    s_add_u32 s12, s12, 65536
    s_lshl_b32 s13, s101, 8
    s_add_u32 s13, s13, s12
    v_lshlrev_b32 v11, 3, v1
    s_mov_b64 s[66:67], -1
    s_mov_b32 s9, 0
L_sp232:
    ds_read_b32 v9, v2 offset:0
    s_waitcnt lgkmcnt(0)
    v_readfirstlane_b32 s8, v9
    s_nop 0
    s_cmp_ge_u32 s8, 4
    s_cbranch_scc1 L_sp232d
    s_add_u32 s9, s9, 1
    s_cmp_lt_u32 s9, 1600000
    s_cbranch_scc1 L_sp232
L_sp232d:
    ds_read_b128 v[32:35], v4 offset:24576
    ds_read_b128 v[36:39], v4 offset:25600
    ds_read_b128 v[40:43], v4 offset:26624
    ds_read_b128 v[44:47], v4 offset:27648
    s_waitcnt lgkmcnt(0)
    v_add_f32 v32, v32, v36
    v_add_f32 v40, v40, v44
    v_add_f32 v33, v33, v37
    v_add_f32 v41, v41, v45
    v_add_f32 v34, v34, v38
    v_add_f32 v42, v42, v46
    v_add_f32 v35, v35, v39
    v_add_f32 v43, v43, v47
    v_add_f32 v32, v32, v40
    v_add_f32 v33, v33, v41
    v_add_f32 v34, v34, v42
    v_add_f32 v35, v35, v43
    v_cvt_pk_bf16_f32 v12, v32, v33
    v_cvt_pk_bf16_f32 v13, v34, v35
    s_mov_b64 exec, 0xffff
    buffer_store_dwordx4 v[12:15], v4, s[48:51], s13 offen sc1
    s_mov_b64 exec, -1
    s_sleep 16
    s_mov_b32 s9, 0
L_sp233:
    ds_read_b32 v9, v2 offset:12
    s_waitcnt lgkmcnt(0)
    v_readfirstlane_b32 s8, v9
    s_nop 0
    s_cmp_ge_u32 s8, 1
    s_cbranch_scc1 L_sp233d
    s_sleep 2
    s_add_u32 s9, s9, 1
    s_cmp_lt_u32 s9, 1600000
    s_cbranch_scc1 L_sp233
L_sp233d:
    s_mov_b32 s9, 0
L_qp1:
    s_mov_b64 exec, s[66:67]
    buffer_load_dwordx4 v[16:19], v4, s[48:51], s12 offen sc1
    s_mov_b64 exec, -1
    s_waitcnt vmcnt(0)
    v_mov_b32 v32, v18
    v_or_b32 v33, 15, v19
    v_cmp_ne_u64 s[66:67], s[52:53], v[32:33]
    s_nop 0
    s_cmp_lg_u64 s[66:67], 0
    s_cbranch_scc0 L_qp2
    s_sleep 12
    s_add_u32 s9, s9, 1
    s_cmp_lt_u32 s9, 400000
    s_cbranch_scc1 L_qp1
L_qp2:
    ds_write_b64 v11, v[16:17] offset:0
    v_cmp_ne_u32 vcc, s14, v19
    s_nop 0
    s_cmp_eq_u64 vcc, 0
    s_cselect_b32 s8, 1, 0
    v_mov_b32 v9, s8
    ds_write_b32 v2, v9 offset:56
    s_waitcnt lgkmcnt(0)
    s_mov_b64 exec, 1
    ds_add_u32 v2, v3 offset:8
    s_mov_b64 exec, -1
L_qdone:
    v_mul_u32_u24 v23, 3584, v5
    v_lshl_add_u32 v23, v6, 4, v23
L_woskip:
    s_cmp_eq_u32 s65, 0
    s_cbranch_scc1 L_wo
    s_mov_b32 s47, 0x20000
    s_mov_b32 s46, 1605632
    s_cmp_eq_u32 s65, 1
    s_cselect_b32 s44, s28, s30
    s_cselect_b32 s45, s29, s31
    s_cmp_eq_u32 s65, 3
    s_cselect_b32 s44, s32, s44
    s_cselect_b32 s45, s33, s45
    s_movk_i32 s12, 3584
    s_cselect_b32 s12, 896, s12
    s_lshl_b32 s8, s64, 7
    s_mul_i32 s9, s99, 401408
    s_lshl_b32 s13, s15, 6
    s_add_u32 s9, s9, s13
    s_cmp_eq_u32 s65, 3
    s_cselect_b32 s8, s9, s8
    s_mul_i32 s9, s11, 112
    s_mul_i32 s9, s9, s12
    s_add_u32 s8, s8, s9
    v_mul_lo_u32 v23, v7, s12
    v_lshl_add_u32 v23, v22, 4, v23
    s_lshl_b32 s12, s12, 3
    s_cmp_eq_u32 s65, 3
    s_cbranch_scc1 L_ftile
    s_mul_i32 s9, s11, 896
    s_add_u32 s40, s16, s9
    s_addc_u32 s41, s17, 0
    s_mov_b32 s42, 896
    s_mov_b32 s43, 0x20000
    buffer_load_dwordx4 v[8:11], v4, s[40:43], 0 offen
L_ftile:
    buffer_load_dwordx4 v[64:67], v23, s[44:47], s8 offen
    s_add_u32 s8, s8, s12
    buffer_load_dwordx4 v[68:71], v23, s[44:47], s8 offen
    s_add_u32 s8, s8, s12
    buffer_load_dwordx4 v[72:75], v23, s[44:47], s8 offen
    s_add_u32 s8, s8, s12
    s_waitcnt vmcnt(2)
    buffer_load_dwordx4 v[76:79], v23, s[44:47], s8 offen
    s_add_u32 s8, s8, s12
    s_waitcnt vmcnt(2)
    buffer_load_dwordx4 v[80:83], v23, s[44:47], s8 offen
    s_add_u32 s8, s8, s12
    s_waitcnt vmcnt(2)
    buffer_load_dwordx4 v[84:87], v23, s[44:47], s8 offen
    s_add_u32 s8, s8, s12
    s_waitcnt vmcnt(2)
    buffer_load_dwordx4 v[88:91], v23, s[44:47], s8 offen
    s_add_u32 s8, s8, s12
    s_waitcnt vmcnt(2)
    buffer_load_dwordx4 v[92:95], v23, s[44:47], s8 offen
    s_add_u32 s8, s8, s12
    s_waitcnt vmcnt(2)
    buffer_load_dwordx4 v[96:99], v23, s[44:47], s8 offen
    s_add_u32 s8, s8, s12
    s_waitcnt vmcnt(2)
    buffer_load_dwordx4 v[100:103], v23, s[44:47], s8 offen
    s_add_u32 s8, s8, s12
    s_waitcnt vmcnt(2)
    buffer_load_dwordx4 v[104:107], v23, s[44:47], s8 offen
    s_add_u32 s8, s8, s12
    s_waitcnt vmcnt(2)
    buffer_load_dwordx4 v[108:111], v23, s[44:47], s8 offen
    s_add_u32 s8, s8, s12
    s_waitcnt vmcnt(2)
    buffer_load_dwordx4 v[112:115], v23, s[44:47], s8 offen
    s_add_u32 s8, s8, s12
    s_waitcnt vmcnt(2)
    buffer_load_dwordx4 v[116:119], v23, s[44:47], s8 offen
    v_lshrrev_b32 v21, 2, v6
    v_lshlrev_b32 v21, 10, v21
    v_and_b32 v12, 1, v6
    v_lshl_add_u32 v12, v5, 1, v12
    v_lshl_add_u32 v21, v12, 1, v21
    s_mul_i32 s13, s11, 224
    v_add_u32 v21, s13, v21
    s_waitcnt vmcnt(0)
    v_perm_b32 v192, v68, v64, s60
    v_perm_b32 v193, v76, v72, s60
    v_perm_b32 v194, v84, v80, s60
    v_perm_b32 v195, v92, v88, s60
    v_perm_b32 v196, v100, v96, s60
    v_perm_b32 v197, v108, v104, s60
    v_perm_b32 v198, v116, v112, s60
    v_perm_b32 v200, v68, v64, s61
    v_perm_b32 v201, v76, v72, s61
    v_perm_b32 v202, v84, v80, s61
    v_perm_b32 v203, v92, v88, s61
    v_perm_b32 v204, v100, v96, s61
    v_perm_b32 v205, v108, v104, s61
    v_perm_b32 v206, v116, v112, s61
    v_perm_b32 v208, v69, v65, s60
    v_perm_b32 v209, v77, v73, s60
    v_perm_b32 v210, v85, v81, s60
    v_perm_b32 v211, v93, v89, s60
    v_perm_b32 v212, v101, v97, s60
    v_perm_b32 v213, v109, v105, s60
    v_perm_b32 v214, v117, v113, s60
    v_perm_b32 v216, v69, v65, s61
    v_perm_b32 v217, v77, v73, s61
    v_perm_b32 v218, v85, v81, s61
    v_perm_b32 v219, v93, v89, s61
    v_perm_b32 v220, v101, v97, s61
    v_perm_b32 v221, v109, v105, s61
    v_perm_b32 v222, v117, v113, s61
    v_perm_b32 v224, v70, v66, s60
    v_perm_b32 v225, v78, v74, s60
    v_perm_b32 v226, v86, v82, s60
    v_perm_b32 v227, v94, v90, s60
    v_perm_b32 v228, v102, v98, s60
    v_perm_b32 v229, v110, v106, s60
    v_perm_b32 v230, v118, v114, s60
    v_perm_b32 v232, v70, v66, s61
    v_perm_b32 v233, v78, v74, s61
    v_perm_b32 v234, v86, v82, s61
    v_perm_b32 v235, v94, v90, s61
    v_perm_b32 v236, v102, v98, s61
    v_perm_b32 v237, v110, v106, s61
    v_perm_b32 v238, v118, v114, s61
    v_perm_b32 v240, v71, v67, s60
    v_perm_b32 v241, v79, v75, s60
    v_perm_b32 v242, v87, v83, s60
    v_perm_b32 v243, v95, v91, s60
    v_perm_b32 v244, v103, v99, s60
    v_perm_b32 v245, v111, v107, s60
    v_perm_b32 v246, v119, v115, s60
    v_perm_b32 v248, v71, v67, s61
    v_perm_b32 v249, v79, v75, s61
    v_perm_b32 v250, v87, v83, s61
    v_perm_b32 v251, v95, v91, s61
    v_perm_b32 v252, v103, v99, s61
    v_perm_b32 v253, v111, v107, s61
    v_perm_b32 v254, v119, v115, s61
    s_cmp_eq_u32 s65, 3
    s_cbranch_scc1 L_wo
    v_lshlrev_b32 v12, 16, v8
    v_and_b32 v13, 0xffff0000, v8
    v_lshlrev_b32 v14, 16, v9
    v_and_b32 v15, 0xffff0000, v9
    v_lshlrev_b32 v16, 16, v10
    v_and_b32 v17, 0xffff0000, v10
    v_lshlrev_b32 v18, 16, v11
    v_and_b32 v19, 0xffff0000, v11
    v_add_f32 v8, v12, v13
    v_add_f32 v9, v14, v15
    v_add_f32 v10, v16, v17
    v_add_f32 v11, v18, v19
    v_add_f32 v8, v8, v9
    v_add_f32 v10, v10, v11
    v_add_f32 v8, v8, v10
    s_nop 1
    v_add_f32_dpp v8, v8, v8 row_ror:8 row_mask:0xf bank_mask:0xf
    s_nop 1
    v_add_f32_dpp v8, v8, v8 row_ror:4 row_mask:0xf bank_mask:0xf
    s_nop 1
    v_add_f32_dpp v8, v8, v8 row_ror:2 row_mask:0xf bank_mask:0xf
    s_nop 1
    v_add_f32_dpp v8, v8, v8 row_ror:1 row_mask:0xf bank_mask:0xf
    v_mov_b32 v9, v8
    s_nop 1
    v_permlane16_swap_b32 v9, v8
    v_add_f32 v8, v8, v9
    v_mov_b32 v9, v8
    s_nop 1
    v_permlane32_swap_b32 v9, v8
    v_add_f32 v8, v8, v9
    v_mul_f32 v8, 0x3b124925, v8
    v_sub_f32 v9, v12, v8
    v_sub_f32 v11, v13, v8
    v_mul_f32 v10, v9, v9
    v_mul_f32 v24, v11, v11
    v_sub_f32 v9, v14, v8
    v_sub_f32 v11, v15, v8
    v_fmac_f32 v10, v9, v9
    v_fmac_f32 v24, v11, v11
    v_sub_f32 v9, v16, v8
    v_sub_f32 v11, v17, v8
    v_fmac_f32 v10, v9, v9
    v_fmac_f32 v24, v11, v11
    v_sub_f32 v9, v18, v8
    v_sub_f32 v11, v19, v8
    v_fmac_f32 v10, v9, v9
    v_fmac_f32 v24, v11, v11
    v_cmp_gt_u32 vcc, 56, v1
    v_add_f32 v10, v10, v24
    s_nop 0
    v_cndmask_b32 v10, 0, v10, vcc
    s_nop 1
    v_add_f32_dpp v10, v10, v10 row_ror:8 row_mask:0xf bank_mask:0xf
    s_nop 1
    v_add_f32_dpp v10, v10, v10 row_ror:4 row_mask:0xf bank_mask:0xf
    s_nop 1
    v_add_f32_dpp v10, v10, v10 row_ror:2 row_mask:0xf bank_mask:0xf
    s_nop 1
    v_add_f32_dpp v10, v10, v10 row_ror:1 row_mask:0xf bank_mask:0xf
    v_mov_b32 v9, v10
    s_nop 1
    v_permlane16_swap_b32 v9, v10
    v_add_f32 v10, v10, v9
    v_mov_b32 v9, v10
    s_nop 1
    v_permlane32_swap_b32 v9, v10
    v_add_f32 v10, v10, v9
    v_mul_f32 v10, 0x3b124925, v10
    v_cvt_pk_bf16_f32 v9, v8, v10
    v_lshlrev_b32 v8, 16, v9
    v_and_b32 v10, 0xffff0000, v9
    v_add_f32 v10, 0x3727c5ac, v10
    v_cvt_pk_bf16_f32 v10, v10, v10
    v_lshlrev_b32 v10, 16, v10
    v_sqrt_f32 v10, v10
    v_sub_f32 v12, v12, v8
    v_sub_f32 v13, v13, v8
    v_sub_f32 v14, v14, v8
    v_sub_f32 v15, v15, v8
    v_sub_f32 v16, v16, v8
    v_sub_f32 v17, v17, v8
    v_sub_f32 v18, v18, v8
    v_sub_f32 v19, v19, v8
    v_cvt_pk_bf16_f32 v10, v10, v10
    v_lshlrev_b32 v10, 16, v10
    v_rcp_f32 v10, v10
    v_cvt_pk_bf16_f32 v24, v12, v13
    v_cvt_pk_bf16_f32 v25, v14, v15
    v_cvt_pk_bf16_f32 v26, v16, v17
    v_cvt_pk_bf16_f32 v27, v18, v19
    v_lshlrev_b32 v12, 16, v24
    v_and_b32 v13, 0xffff0000, v24
    v_lshlrev_b32 v14, 16, v25
    v_and_b32 v15, 0xffff0000, v25
    v_lshlrev_b32 v16, 16, v26
    v_and_b32 v17, 0xffff0000, v26
    v_lshlrev_b32 v18, 16, v27
    v_and_b32 v19, 0xffff0000, v27
    v_mul_f32 v12, v12, v10
    v_mul_f32 v13, v13, v10
    v_mul_f32 v14, v14, v10
    v_mul_f32 v15, v15, v10
    v_mul_f32 v16, v16, v10
    v_mul_f32 v17, v17, v10
    v_mul_f32 v18, v18, v10
    v_mul_f32 v19, v19, v10
    v_cvt_pk_bf16_f32 v24, v12, v13
    v_cvt_pk_bf16_f32 v25, v14, v15
    v_cvt_pk_bf16_f32 v26, v16, v17
    v_cvt_pk_bf16_f32 v27, v18, v19
    s_lshl_b32 s8, s11, 10
    v_add_u32 v9, s8, v4
    ds_write_b128 v9, v[24:27] offset:2048
    s_waitcnt lgkmcnt(0)
    s_mov_b64 exec, 1
    ds_add_u32 v2, v3 offset:4
    s_mov_b64 exec, -1
    s_mov_b32 s9, 0
L_sp234:
    ds_read_b32 v9, v2 offset:4
    s_waitcnt lgkmcnt(0)
    v_readfirstlane_b32 s8, v9
    s_nop 0
    s_cmp_ge_u32 s8, 4
    s_cbranch_scc1 L_sp234d
    s_sleep 1
    s_add_u32 s9, s9, 1
    s_cmp_lt_u32 s9, 1600000
    s_cbranch_scc1 L_sp234
L_sp234d:
    s_branch L_fmul
L_wo:
    s_mov_b32 s9, 0
L_sp235:
    ds_read_b32 v9, v2 offset:12
    s_waitcnt lgkmcnt(0)
    v_readfirstlane_b32 s8, v9
    s_nop 0
    s_cmp_ge_u32 s8, 2
    s_cbranch_scc1 L_sp235d
    s_sleep 2
    s_add_u32 s9, s9, 1
    s_cmp_lt_u32 s9, 1600000
    s_cbranch_scc1 L_sp235
L_sp235d:
    v_mul_u32_u24 v23, 3584, v5
    v_lshl_add_u32 v23, v6, 4, v23
    s_mov_b32 s44, s24
    s_mov_b32 s45, s25
    s_mov_b32 s46, 3670016
    s_mov_b32 s47, 0x20000
    s_lshl_b32 s8, s5, 2
    s_add_u32 s8, s8, s6
    s_mul_i32 s8, s8, 57344
    s_lshl_b32 s9, s11, 8
    s_add_u32 s8, s8, s9
    s_mov_b64 exec, s[74:75]
    buffer_load_dwordx4 v[64:67], v23, s[44:47], s8 offen offset:0
    buffer_load_dwordx4 v[68:71], v23, s[44:47], s8 offen offset:896
    s_waitcnt vmcnt(1)
    buffer_load_dwordx4 v[72:75], v23, s[44:47], s8 offen offset:1792
    s_waitcnt vmcnt(1)
    buffer_load_dwordx4 v[76:79], v23, s[44:47], s8 offen offset:2688
    s_addk_i32 s8, 14336
    s_waitcnt vmcnt(1)
    buffer_load_dwordx4 v[80:83], v23, s[44:47], s8 offen offset:0
    s_waitcnt vmcnt(1)
    buffer_load_dwordx4 v[84:87], v23, s[44:47], s8 offen offset:896
    s_waitcnt vmcnt(1)
    buffer_load_dwordx4 v[88:91], v23, s[44:47], s8 offen offset:1792
    s_waitcnt vmcnt(1)
    buffer_load_dwordx4 v[92:95], v23, s[44:47], s8 offen offset:2688
    s_addk_i32 s8, 14336
    s_waitcnt vmcnt(1)
    buffer_load_dwordx4 v[96:99], v23, s[44:47], s8 offen offset:0
    s_waitcnt vmcnt(1)
    buffer_load_dwordx4 v[100:103], v23, s[44:47], s8 offen offset:896
    s_waitcnt vmcnt(1)
    buffer_load_dwordx4 v[104:107], v23, s[44:47], s8 offen offset:1792
    s_waitcnt vmcnt(1)
    buffer_load_dwordx4 v[108:111], v23, s[44:47], s8 offen offset:2688
    s_addk_i32 s8, 14336
    s_waitcnt vmcnt(1)
    buffer_load_dwordx4 v[112:115], v23, s[44:47], s8 offen offset:0
    s_waitcnt vmcnt(1)
    buffer_load_dwordx4 v[116:119], v23, s[44:47], s8 offen offset:896
    s_waitcnt vmcnt(1)
    buffer_load_dwordx4 v[120:123], v23, s[44:47], s8 offen offset:1792
    s_waitcnt vmcnt(1)
    buffer_load_dwordx4 v[124:127], v23, s[44:47], s8 offen offset:2688
    s_mov_b64 exec, -1
    s_waitcnt vmcnt(0)
    v_perm_b32 v128, v68, v64, s60
    v_perm_b32 v129, v76, v72, s60
    v_perm_b32 v130, v84, v80, s60
    v_perm_b32 v131, v92, v88, s60
    v_perm_b32 v132, v100, v96, s60
    v_perm_b32 v133, v108, v104, s60
    v_perm_b32 v134, v116, v112, s60
    v_perm_b32 v135, v124, v120, s60
    v_perm_b32 v136, v68, v64, s61
    v_perm_b32 v137, v76, v72, s61
    v_perm_b32 v138, v84, v80, s61
    v_perm_b32 v139, v92, v88, s61
    v_perm_b32 v140, v100, v96, s61
    v_perm_b32 v141, v108, v104, s61
    v_perm_b32 v142, v116, v112, s61
    v_perm_b32 v143, v124, v120, s61
    v_perm_b32 v144, v69, v65, s60
    v_perm_b32 v145, v77, v73, s60
    v_perm_b32 v146, v85, v81, s60
    v_perm_b32 v147, v93, v89, s60
    v_perm_b32 v148, v101, v97, s60
    v_perm_b32 v149, v109, v105, s60
    v_perm_b32 v150, v117, v113, s60
    v_perm_b32 v151, v125, v121, s60
    v_perm_b32 v152, v69, v65, s61
    v_perm_b32 v153, v77, v73, s61
    v_perm_b32 v154, v85, v81, s61
    v_perm_b32 v155, v93, v89, s61
    v_perm_b32 v156, v101, v97, s61
    v_perm_b32 v157, v109, v105, s61
    v_perm_b32 v158, v117, v113, s61
    v_perm_b32 v159, v125, v121, s61
    v_perm_b32 v160, v70, v66, s60
    v_perm_b32 v161, v78, v74, s60
    v_perm_b32 v162, v86, v82, s60
    v_perm_b32 v163, v94, v90, s60
    v_perm_b32 v164, v102, v98, s60
    v_perm_b32 v165, v110, v106, s60
    v_perm_b32 v166, v118, v114, s60
    v_perm_b32 v167, v126, v122, s60
    v_perm_b32 v168, v70, v66, s61
    v_perm_b32 v169, v78, v74, s61
    v_perm_b32 v170, v86, v82, s61
    v_perm_b32 v171, v94, v90, s61
    v_perm_b32 v172, v102, v98, s61
    v_perm_b32 v173, v110, v106, s61
    v_perm_b32 v174, v118, v114, s61
    v_perm_b32 v175, v126, v122, s61
    v_perm_b32 v176, v71, v67, s60
    v_perm_b32 v177, v79, v75, s60
    v_perm_b32 v178, v87, v83, s60
    v_perm_b32 v179, v95, v91, s60
    v_perm_b32 v180, v103, v99, s60
    v_perm_b32 v181, v111, v107, s60
    v_perm_b32 v182, v119, v115, s60
    v_perm_b32 v183, v127, v123, s60
    v_perm_b32 v184, v71, v67, s61
    v_perm_b32 v185, v79, v75, s61
    v_perm_b32 v186, v87, v83, s61
    v_perm_b32 v187, v95, v91, s61
    v_perm_b32 v188, v103, v99, s61
    v_perm_b32 v189, v111, v107, s61
    v_perm_b32 v190, v119, v115, s61
    v_perm_b32 v191, v127, v123, s61
    s_cmp_lg_u32 s65, 3
    s_cbranch_scc1 L_mid
    s_mul_i32 s13, s11, 224
L_geglu:
    v_lshrrev_b32 v10, 5, v1
    v_and_b32 v12, 31, v1
    v_lshlrev_b32 v11, 13, v10
    v_lshl_add_u32 v11, v12, 4, v11
    v_lshlrev_b32 v10, 10, v10
    v_lshl_add_u32 v10, v12, 3, v10
    v_add_u32 v10, s13, v10
    s_lshl_b32 s8, s99, 2
    s_add_u32 s8, s8, s11
    s_mul_i32 s8, s8, 448
    s_add_u32 s20, s8, 131072
    s_add_u32 s21, s8, 147456
    s_add_u32 s22, s8, 163840
    s_add_u32 s23, s8, 180224
    v_mov_b32 v34, s52
    v_mov_b32 v35, s53
    s_mov_b32 s66, 0x0fffffff
    s_mov_b32 s67, 0x0fffffff
    v_mov_b32 v38, s52
    v_mov_b32 v39, s53
    s_mov_b32 s68, 0x0fffffff
    s_mov_b32 s69, 0x0fffffff
    v_mov_b32 v42, s52
    v_mov_b32 v43, s53
    s_mov_b32 s76, 0x0fffffff
    s_mov_b32 s77, 0x0fffffff
    v_mov_b32 v46, s52
    v_mov_b32 v47, s53
    s_mov_b32 s78, 0x0fffffff
    s_mov_b32 s79, 0x0fffffff
    s_waitcnt lgkmcnt(0)
    s_mov_b64 exec, 1
    ds_add_u32 v2, v3 offset:4
    s_mov_b64 exec, -1
    s_mov_b32 s9, 0
L_sp236:
    ds_read_b32 v9, v2 offset:4
    s_waitcnt lgkmcnt(0)
    v_readfirstlane_b32 s8, v9
    s_nop 0
    s_cmp_ge_u32 s8, 4
    s_cbranch_scc1 L_sp236d
    s_sleep 1
    s_add_u32 s9, s9, 1
    s_cmp_lt_u32 s9, 1600000
    s_cbranch_scc1 L_sp236
L_sp236d:
    s_mov_b32 s9, 0
L_sp237:
    ds_read_b32 v9, v2 offset:12
    s_waitcnt lgkmcnt(0)
    v_readfirstlane_b32 s8, v9
    s_nop 0
    s_cmp_ge_u32 s8, 3
    s_cbranch_scc1 L_sp237d
    s_sleep 8
    s_add_u32 s9, s9, 1
    s_cmp_lt_u32 s9, 1600000
    s_cbranch_scc1 L_sp237
L_sp237d:
    s_mov_b32 s9, 0
L_gu1:
    s_mov_b64 exec, s[66:67]
    buffer_load_dwordx4 v[32:35], v11, s[48:51], s20 offen sc1
    s_mov_b64 exec, s[68:69]
    buffer_load_dwordx4 v[36:39], v11, s[48:51], s21 offen sc1
    s_mov_b64 exec, s[76:77]
    buffer_load_dwordx4 v[40:43], v11, s[48:51], s22 offen sc1
    s_mov_b64 exec, s[78:79]
    buffer_load_dwordx4 v[44:47], v11, s[48:51], s23 offen sc1
    s_mov_b64 exec, -1
    s_waitcnt vmcnt(3)
    v_cmp_ne_u64 s[66:67], s[52:53], v[34:35]
    s_waitcnt vmcnt(2)
    v_cmp_ne_u64 s[68:69], s[52:53], v[38:39]
    s_waitcnt vmcnt(1)
    v_cmp_ne_u64 s[76:77], s[52:53], v[42:43]
    s_waitcnt vmcnt(0)
    v_cmp_ne_u64 s[78:79], s[52:53], v[46:47]
    s_nop 0
    s_or_b64 vcc, s[66:67], s[68:69]
    s_or_b64 vcc, vcc, s[76:77]
    s_or_b64 vcc, vcc, s[78:79]
    s_cbranch_scc0 L_gu2
    s_sleep 32
    s_add_u32 s9, s9, 1
    s_cmp_lt_u32 s9, 400000
    s_cbranch_scc1 L_gu1
L_gu2:
    s_mov_b32 s8, 0x3d372713
    s_mov_b32 s9, 0xc0135761
    v_lshlrev_b32 v48, 16, v32
    v_and_b32 v49, 0xffff0000, v32
    v_lshlrev_b32 v50, 16, v33
    v_and_b32 v51, 0xffff0000, v33
    v_lshlrev_b32 v52, 16, v40
    v_and_b32 v53, 0xffff0000, v40
    v_lshlrev_b32 v54, 16, v41
    v_and_b32 v55, 0xffff0000, v41
    v_mul_f32 v56, v48, v48
    v_mul_f32 v57, v49, v49
    v_mul_f32 v58, v50, v50
    v_mul_f32 v59, v51, v51
    v_mul_f32 v56, v56, v48
    v_mul_f32 v57, v57, v49
    v_mul_f32 v58, v58, v50
    v_mul_f32 v59, v59, v51
    v_fma_f32 v56, v56, s8, v48
    v_fma_f32 v57, v57, s8, v49
    v_fma_f32 v58, v58, s8, v50
    v_fma_f32 v59, v59, s8, v51
    v_mul_f32 v56, s9, v56
    v_mul_f32 v57, s9, v57
    v_mul_f32 v58, s9, v58
    v_mul_f32 v59, s9, v59
    v_exp_f32 v56, v56
    v_exp_f32 v57, v57
    v_exp_f32 v58, v58
    v_exp_f32 v59, v59
    v_add_f32 v56, 1.0, v56
    v_add_f32 v57, 1.0, v57
    v_add_f32 v58, 1.0, v58
    v_add_f32 v59, 1.0, v59
    v_rcp_f32 v56, v56
    v_rcp_f32 v57, v57
    v_rcp_f32 v58, v58
    v_rcp_f32 v59, v59
    v_mul_f32 v48, v48, v56
    v_mul_f32 v49, v49, v57
    v_mul_f32 v50, v50, v58
    v_mul_f32 v51, v51, v59
    v_cvt_pk_bf16_f32 v56, v48, v49
    v_cvt_pk_bf16_f32 v57, v50, v51
    v_lshlrev_b32 v48, 16, v56
    v_and_b32 v49, 0xffff0000, v56
    v_lshlrev_b32 v50, 16, v57
    v_and_b32 v51, 0xffff0000, v57
    v_mul_f32 v48, v48, v52
    v_mul_f32 v49, v49, v53
    v_mul_f32 v50, v50, v54
    v_mul_f32 v51, v51, v55
    v_cvt_pk_bf16_f32 v12, v48, v49
    v_cvt_pk_bf16_f32 v13, v50, v51
    s_mov_b32 exec_lo, 0x0fffffff
    s_mov_b32 exec_hi, 0x0fffffff
    ds_write_b64 v10, v[12:13] offset:2048
    s_mov_b64 exec, -1
    s_nop 1
    v_lshlrev_b32 v48, 16, v36
    v_and_b32 v49, 0xffff0000, v36
    v_lshlrev_b32 v50, 16, v37
    v_and_b32 v51, 0xffff0000, v37
    v_lshlrev_b32 v52, 16, v44
    v_and_b32 v53, 0xffff0000, v44
    v_lshlrev_b32 v54, 16, v45
    v_and_b32 v55, 0xffff0000, v45
    v_mul_f32 v56, v48, v48
    v_mul_f32 v57, v49, v49
    v_mul_f32 v58, v50, v50
    v_mul_f32 v59, v51, v51
    v_mul_f32 v56, v56, v48
    v_mul_f32 v57, v57, v49
    v_mul_f32 v58, v58, v50
    v_mul_f32 v59, v59, v51
    v_fma_f32 v56, v56, s8, v48
    v_fma_f32 v57, v57, s8, v49
    v_fma_f32 v58, v58, s8, v50
    v_fma_f32 v59, v59, s8, v51
    v_mul_f32 v56, s9, v56
    v_mul_f32 v57, s9, v57
    v_mul_f32 v58, s9, v58
    v_mul_f32 v59, s9, v59
    v_exp_f32 v56, v56
    v_exp_f32 v57, v57
    v_exp_f32 v58, v58
    v_exp_f32 v59, v59
    v_add_f32 v56, 1.0, v56
    v_add_f32 v57, 1.0, v57
    v_add_f32 v58, 1.0, v58
    v_add_f32 v59, 1.0, v59
    v_rcp_f32 v56, v56
    v_rcp_f32 v57, v57
    v_rcp_f32 v58, v58
    v_rcp_f32 v59, v59
    v_mul_f32 v48, v48, v56
    v_mul_f32 v49, v49, v57
    v_mul_f32 v50, v50, v58
    v_mul_f32 v51, v51, v59
    v_cvt_pk_bf16_f32 v56, v48, v49
    v_cvt_pk_bf16_f32 v57, v50, v51
    v_lshlrev_b32 v48, 16, v56
    v_and_b32 v49, 0xffff0000, v56
    v_lshlrev_b32 v50, 16, v57
    v_and_b32 v51, 0xffff0000, v57
    v_mul_f32 v48, v48, v52
    v_mul_f32 v49, v49, v53
    v_mul_f32 v50, v50, v54
    v_mul_f32 v51, v51, v55
    v_cvt_pk_bf16_f32 v12, v48, v49
    v_cvt_pk_bf16_f32 v13, v50, v51
    s_mov_b32 exec_lo, 0x0fffffff
    s_mov_b32 exec_hi, 0x0fffffff
    ds_write_b64 v10, v[12:13] offset:4096
    s_mov_b64 exec, -1
    s_nop 1
L_fmul:
    ds_read_u16 v32, v21 offset:2048
    ds_read_u16 v33, v21 offset:2064
    ds_read_u16 v34, v21 offset:2080
    ds_read_u16 v35, v21 offset:2096
    ds_read_u16 v36, v21 offset:2112
    ds_read_u16 v37, v21 offset:2128
    ds_read_u16 v38, v21 offset:2144
    ds_read_u16 v39, v21 offset:2160
    ds_read_u16 v40, v21 offset:2176
    ds_read_u16 v41, v21 offset:2192
    ds_read_u16 v42, v21 offset:2208
    ds_read_u16 v43, v21 offset:2224
    ds_read_u16 v44, v21 offset:2240
    ds_read_u16 v45, v21 offset:2256
    s_waitcnt lgkmcnt(0)
    v_lshl_or_b32 v24, v33, 16, v32
    v_lshl_or_b32 v25, v35, 16, v34
    v_lshl_or_b32 v26, v37, 16, v36
    v_lshl_or_b32 v27, v39, 16, v38
    v_lshl_or_b32 v28, v41, 16, v40
    v_lshl_or_b32 v29, v43, 16, v42
    v_lshl_or_b32 v30, v45, 16, v44
    v_mov_b32 v31, 0
    v_mfma_f32_16x16x32_bf16 v[32:35], v[24:27], v[192:195], 0
    v_mfma_f32_16x16x32_bf16 v[36:39], v[24:27], v[200:203], 0
    v_mfma_f32_16x16x32_bf16 v[40:43], v[24:27], v[208:211], 0
    v_mfma_f32_16x16x32_bf16 v[44:47], v[24:27], v[216:219], 0
    v_mfma_f32_16x16x32_bf16 v[48:51], v[24:27], v[224:227], 0
    v_mfma_f32_16x16x32_bf16 v[52:55], v[24:27], v[232:235], 0
    v_mfma_f32_16x16x32_bf16 v[56:59], v[24:27], v[240:243], 0
    v_mfma_f32_16x16x32_bf16 v[60:63], v[24:27], v[248:251], 0
    v_mfma_f32_16x16x32_bf16 v[32:35], v[28:31], v[196:199], v[32:35]
    v_mfma_f32_16x16x32_bf16 v[36:39], v[28:31], v[204:207], v[36:39]
    v_mfma_f32_16x16x32_bf16 v[40:43], v[28:31], v[212:215], v[40:43]
    v_mfma_f32_16x16x32_bf16 v[44:47], v[28:31], v[220:223], v[44:47]
    v_mfma_f32_16x16x32_bf16 v[48:51], v[28:31], v[228:231], v[48:51]
    v_mfma_f32_16x16x32_bf16 v[52:55], v[28:31], v[236:239], v[52:55]
    v_mfma_f32_16x16x32_bf16 v[56:59], v[28:31], v[244:247], v[56:59]
    v_mfma_f32_16x16x32_bf16 v[60:63], v[28:31], v[252:255], v[60:63]
    s_nop 0
    v_add_f32_dpp v12, v33, v32 row_ror:8 row_mask:0xf bank_mask:0x3
    s_nop 2
    v_add_f32_dpp v12, v48, v49 row_ror:8 row_mask:0xf bank_mask:0xc
    v_add_f32_dpp v13, v37, v36 row_ror:8 row_mask:0xf bank_mask:0x3
    s_nop 1
    v_add_f32_dpp v13, v52, v53 row_ror:8 row_mask:0xf bank_mask:0xc
    v_add_f32_dpp v14, v41, v40 row_ror:8 row_mask:0xf bank_mask:0x3
    s_nop 1
    v_add_f32_dpp v14, v56, v57 row_ror:8 row_mask:0xf bank_mask:0xc
    v_add_f32_dpp v15, v45, v44 row_ror:8 row_mask:0xf bank_mask:0x3
    s_nop 1
    v_add_f32_dpp v15, v60, v61 row_ror:8 row_mask:0xf bank_mask:0xc
    ds_write_b128 v20, v[12:15] offset:28672
    s_waitcnt lgkmcnt(0)
    s_mov_b64 exec, 1
    ds_add_u32 v2, v3 offset:4
    s_mov_b64 exec, -1
    s_cmp_eq_u32 s11, 0
    s_cbranch_scc1 L_fpub
    s_cmp_eq_u32 s65, 3
    s_cbranch_scc1 L_mid
    s_branch L_wo
L_fpub:
    v_mov_b32 v14, s52
    v_mov_b32 v15, s53
    v_mov_b32 v18, s52
    v_mov_b32 v19, s53
    s_mov_b32 s9, 0
L_sp238:
    ds_read_b32 v9, v2 offset:4
    s_waitcnt lgkmcnt(0)
    v_readfirstlane_b32 s8, v9
    s_nop 0
    s_cmp_ge_u32 s8, 8
    s_cbranch_scc1 L_sp238d
    s_sleep 1
    s_add_u32 s9, s9, 1
    s_cmp_lt_u32 s9, 1600000
    s_cbranch_scc1 L_sp238
L_sp238d:
    ds_read_b128 v[32:35], v4 offset:28672
    ds_read_b128 v[36:39], v4 offset:29696
    ds_read_b128 v[40:43], v4 offset:30720
    ds_read_b128 v[44:47], v4 offset:31744
    s_waitcnt lgkmcnt(0)
    v_add_f32 v32, v32, v36
    v_add_f32 v40, v40, v44
    v_add_f32 v33, v33, v37
    v_add_f32 v41, v41, v45
    v_add_f32 v34, v34, v38
    v_add_f32 v42, v42, v46
    v_add_f32 v35, v35, v39
    v_add_f32 v43, v43, v47
    v_add_f32 v32, v32, v40
    v_add_f32 v33, v33, v41
    v_add_f32 v34, v34, v42
    v_add_f32 v35, v35, v43
    v_cvt_pk_bf16_f32 v12, v32, v33
    v_cvt_pk_bf16_f32 v13, v34, v35
    s_cmp_eq_u32 s65, 3
    s_cbranch_scc1 L_fdown
    v_lshlrev_b32 v11, 13, v5
    v_lshl_add_u32 v11, v6, 4, v11
    s_lshl_b32 s12, s65, 15
    s_lshl_b32 s8, s64, 8
    s_add_u32 s12, s12, s8
    s_add_u32 s12, s12, 98304
    buffer_store_dwordx4 v[12:15], v11, s[48:51], s12 offen sc1
    s_branch L_wo
L_fdown:
    v_lshlrev_b32 v10, 3, v1
    v_lshrrev_b32 v11, 5, v1
    v_lshlrev_b32 v11, 14, v11
    v_and_b32 v9, 31, v1
    v_lshl_add_u32 v11, v9, 4, v11
    s_lshl_b32 s12, s99, 12
    s_lshl_b32 s8, s15, 8
    s_add_u32 s12, s12, s8
    s_add_u32 s12, s12, 262144
    s_add_u32 s13, s12, 0x8000
    ds_read_b64 v[32:33], v10 offset:28672
    ds_read_b64 v[34:35], v10 offset:29696
    ds_read_b64 v[36:37], v10 offset:30720
    ds_read_b64 v[38:39], v10 offset:31744
    ds_read_b64 v[40:41], v10 offset:29184
    ds_read_b64 v[42:43], v10 offset:30208
    ds_read_b64 v[44:45], v10 offset:31232
    ds_read_b64 v[46:47], v10 offset:32256
    s_waitcnt lgkmcnt(0)
    v_add_f32 v32, v32, v34
    v_add_f32 v36, v36, v38
    v_add_f32 v33, v33, v35
    v_add_f32 v37, v37, v39
    v_add_f32 v12, v32, v36
    v_add_f32 v13, v33, v37
    v_add_f32 v40, v40, v42
    v_add_f32 v44, v44, v46
    v_add_f32 v41, v41, v43
    v_add_f32 v45, v45, v47
    v_add_f32 v16, v40, v44
    v_add_f32 v17, v41, v45
    buffer_store_dwordx4 v[12:15], v11, s[48:51], s12 offen sc1
    buffer_store_dwordx4 v[16:19], v11, s[48:51], s13 offen sc1
L_mid:
    v_lshlrev_b32 v20, 6, v6
    v_lshl_add_u32 v20, v5, 4, v20
    s_lshl_b32 s8, s11, 2
    v_add_u32 v7, s8, v2
    s_lshl_b32 s8, s11, 10
    v_add_u32 v10, s8, v4
    v_mul_u32_u24 v21, 272, v5
    v_lshl_add_u32 v21, v6, 4, v21
    s_mul_i32 s8, s11, 2304
    v_add_u32 v21, s8, v21
    v_lshlrev_b32 v11, 3, v1
    v_lshlrev_b32 v22, 4, v6
    s_lshl_b32 s12, s7, 13
    s_add_u32 s12, s12, 524288
    s_lshl_b32 s9, s11, 11
    s_add_u32 s12, s12, s9
    s_lshl_b32 s9, s100, 9
    s_add_u32 s13, s12, s9
    s_lshl_b32 s14, s7, 8
    s_add_u32 s14, s14, 196608
    s_lshl_b32 s8, s11, 2
    s_add_u32 s8, s8, s6
    s_lshl_b32 s8, s8, 4
    s_add_u32 s15, s14, s8
    v_mov_b32 v18, s52
    v_mov_b32 v19, s53
    s_mov_b64 s[66:67], -1
    s_mov_b32 s9, 0
L_sp239:
    ds_read_b32 v9, v7 offset:16
    s_waitcnt lgkmcnt(0)
    v_readfirstlane_b32 s8, v9
    s_nop 0
    s_cmp_ge_u32 s8, 1
    s_cbranch_scc1 L_sp239d
    s_sleep 2
    s_add_u32 s9, s9, 1
    s_cmp_lt_u32 s9, 1600000
    s_cbranch_scc1 L_sp239
L_sp239d:
    ds_read_b128 v[32:35], v10 offset:8192
    ds_read_b32 v9, v2 offset:56
    v_add_u32 v14, v10, v4
    s_mov_b32 exec_hi, 0
    ds_read_b128 v[40:43], v14 offset:8192
    ds_read_b128 v[44:47], v14 offset:8208
    s_waitcnt lgkmcnt(0)
    v_cvt_pk_bf16_f32 v48, v40, v41
    v_cvt_pk_bf16_f32 v49, v42, v43
    v_cvt_pk_bf16_f32 v50, v44, v45
    v_cvt_pk_bf16_f32 v51, v46, v47
    v_readfirstlane_b32 s10, v9
    s_nop 0
    s_cmp_eq_u32 s10, 1
    s_cbranch_scc1 L_xs_a
    buffer_store_dwordx4 v[48:51], v4, s[48:51], s13 offen sc1
    s_branch L_xs_b
L_xs_a:
    buffer_store_dwordx4 v[48:51], v4, s[48:51], s13 offen
L_xs_b:
    s_mov_b32 exec_hi, -1
    s_waitcnt lgkmcnt(0)
    v_cvt_pk_bf16_f32 v12, v32, v33
    v_cvt_pk_bf16_f32 v13, v34, v35
    v_lshlrev_b32 v32, 16, v12
    v_and_b32 v33, 0xffff0000, v12
    v_lshlrev_b32 v34, 16, v13
    v_and_b32 v35, 0xffff0000, v13
    v_max3_f32 v16, v32, v33, v34
    v_max_f32 v16, v16, v35
    v_max_f32 v16, 0xff7fffff, v16
    s_nop 1
    v_max_f32_dpp v16, v16, v16 row_ror:8 row_mask:0xf bank_mask:0xf
    s_nop 1
    v_max_f32_dpp v16, v16, v16 row_ror:4 row_mask:0xf bank_mask:0xf
    s_nop 1
    v_max_f32_dpp v16, v16, v16 row_ror:2 row_mask:0xf bank_mask:0xf
    s_nop 1
    v_max_f32_dpp v16, v16, v16 row_ror:1 row_mask:0xf bank_mask:0xf
    v_mov_b32 v9, v16
    s_nop 1
    v_permlane16_swap_b32 v9, v16
    v_max_f32 v16, v16, v9
    v_mov_b32 v9, v16
    s_nop 1
    v_permlane32_swap_b32 v9, v16
    v_max_f32 v16, v16, v9
    v_sub_f32 v32, v32, v16
    v_sub_f32 v33, v33, v16
    v_sub_f32 v34, v34, v16
    v_sub_f32 v35, v35, v16
    v_mul_f32 v32, s62, v32
    v_mul_f32 v33, s62, v33
    v_mul_f32 v34, s62, v34
    v_mul_f32 v35, s62, v35
    v_exp_f32 v32, v32
    v_exp_f32 v33, v33
    v_exp_f32 v34, v34
    v_exp_f32 v35, v35
    v_add_f32 v17, v32, v33
    v_add_f32 v34, v34, v35
    v_add_f32 v17, v17, v34
    s_nop 1
    v_add_f32_dpp v17, v17, v17 row_ror:8 row_mask:0xf bank_mask:0xf
    s_nop 1
    v_add_f32_dpp v17, v17, v17 row_ror:4 row_mask:0xf bank_mask:0xf
    s_nop 1
    v_add_f32_dpp v17, v17, v17 row_ror:2 row_mask:0xf bank_mask:0xf
    s_nop 1
    v_add_f32_dpp v17, v17, v17 row_ror:1 row_mask:0xf bank_mask:0xf
    v_mov_b32 v9, v17
    s_nop 1
    v_permlane16_swap_b32 v9, v17
    v_add_f32 v17, v17, v9
    v_mov_b32 v9, v17
    s_nop 1
    v_permlane32_swap_b32 v9, v17
    v_add_f32 v17, v17, v9
    s_waitcnt vmcnt(0)
    s_mov_b64 exec, 1
    s_cmp_eq_u32 s10, 1
    s_cbranch_scc1 L_xs_c
    buffer_store_dwordx4 v[16:19], off, s[48:51], s15 sc1
    s_branch L_xs_d
L_xs_c:
    buffer_store_dwordx4 v[16:19], off, s[48:51], s15
L_xs_d:
    s_mov_b64 exec, -1
    s_mov_b32 s9, 0
L_sp240:
    ds_read_b32 v9, v7 offset:16
    s_waitcnt lgkmcnt(0)
    v_readfirstlane_b32 s8, v9
    s_nop 0
    s_cmp_ge_u32 s8, 2
    s_cbranch_scc1 L_sp240d
    s_sleep 2
    s_add_u32 s9, s9, 1
    s_cmp_lt_u32 s9, 1600000
    s_cbranch_scc1 L_sp240
L_sp240d:
    s_mov_b32 s9, 0
L_st1:
    s_mov_b64 exec, s[66:67]
    buffer_load_dwordx4 v[12:15], v22, s[48:51], s14 offen sc1
    s_mov_b64 exec, -1
    s_waitcnt vmcnt(0)
    v_cmp_ne_u64 s[66:67], s[52:53], v[14:15]
    s_nop 0
    s_cmp_lg_u64 s[66:67], 0
    s_cbranch_scc0 L_st2
    s_sleep 16
    s_add_u32 s9, s9, 1
    s_cmp_lt_u32 s9, 400000
    s_cbranch_scc1 L_st1
L_st2:
    buffer_load_dwordx4 v[32:35], v4, s[48:51], s12 offen offset:0 sc1
    buffer_load_dwordx4 v[36:39], v4, s[48:51], s12 offen offset:1024 sc1
    v_mov_b32 v14, v12
    s_nop 1
    v_max_f32_dpp v14, v14, v14 row_ror:8 row_mask:0xf bank_mask:0xf
    s_nop 1
    v_max_f32_dpp v14, v14, v14 row_ror:4 row_mask:0xf bank_mask:0xf
    s_nop 1
    v_max_f32_dpp v14, v14, v14 row_ror:2 row_mask:0xf bank_mask:0xf
    s_nop 1
    v_max_f32_dpp v14, v14, v14 row_ror:1 row_mask:0xf bank_mask:0xf
    v_sub_f32 v12, v12, v14
    v_mul_f32 v12, s62, v12
    v_exp_f32 v12, v12
    s_nop 0
    v_mul_f32 v13, v13, v12
    s_nop 1
    v_add_f32_dpp v13, v13, v13 row_ror:8 row_mask:0xf bank_mask:0xf
    s_nop 1
    v_add_f32_dpp v13, v13, v13 row_ror:4 row_mask:0xf bank_mask:0xf
    s_nop 1
    v_add_f32_dpp v13, v13, v13 row_ror:2 row_mask:0xf bank_mask:0xf
    s_nop 1
    v_add_f32_dpp v13, v13, v13 row_ror:1 row_mask:0xf bank_mask:0xf
    v_rcp_f32 v13, v13
    s_waitcnt vmcnt(1)
    v_lshlrev_b32 v40, 16, v32
    v_and_b32 v41, 0xffff0000, v32
    v_lshlrev_b32 v42, 16, v33
    v_and_b32 v43, 0xffff0000, v33
    v_lshlrev_b32 v44, 16, v34
    v_and_b32 v45, 0xffff0000, v34
    v_lshlrev_b32 v46, 16, v35
    v_and_b32 v47, 0xffff0000, v35
    v_sub_f32 v40, v40, v14
    v_sub_f32 v41, v41, v14
    v_sub_f32 v42, v42, v14
    v_sub_f32 v43, v43, v14
    v_sub_f32 v44, v44, v14
    v_sub_f32 v45, v45, v14
    v_sub_f32 v46, v46, v14
    v_sub_f32 v47, v47, v14
    v_mul_f32 v40, s62, v40
    v_mul_f32 v41, s62, v41
    v_mul_f32 v42, s62, v42
    v_mul_f32 v43, s62, v43
    v_mul_f32 v44, s62, v44
    v_mul_f32 v45, s62, v45
    v_mul_f32 v46, s62, v46
    v_mul_f32 v47, s62, v47
    v_exp_f32 v40, v40
    v_exp_f32 v41, v41
    v_exp_f32 v42, v42
    v_exp_f32 v43, v43
    v_exp_f32 v44, v44
    v_exp_f32 v45, v45
    v_exp_f32 v46, v46
    v_exp_f32 v47, v47
    v_mul_f32 v40, v40, v13
    v_mul_f32 v41, v41, v13
    v_mul_f32 v42, v42, v13
    v_mul_f32 v43, v43, v13
    v_mul_f32 v44, v44, v13
    v_mul_f32 v45, v45, v13
    v_mul_f32 v46, v46, v13
    v_mul_f32 v47, v47, v13
    v_cvt_pk_bf16_f32 v32, v40, v41
    v_cvt_pk_bf16_f32 v33, v42, v43
    v_cvt_pk_bf16_f32 v34, v44, v45
    v_cvt_pk_bf16_f32 v35, v46, v47
    ds_write_b128 v21, v[32:35] offset:12288
    s_waitcnt vmcnt(0)
    v_lshlrev_b32 v40, 16, v36
    v_and_b32 v41, 0xffff0000, v36
    v_lshlrev_b32 v42, 16, v37
    v_and_b32 v43, 0xffff0000, v37
    v_lshlrev_b32 v44, 16, v38
    v_and_b32 v45, 0xffff0000, v38
    v_lshlrev_b32 v46, 16, v39
    v_and_b32 v47, 0xffff0000, v39
    v_sub_f32 v40, v40, v14
    v_sub_f32 v41, v41, v14
    v_sub_f32 v42, v42, v14
    v_sub_f32 v43, v43, v14
    v_sub_f32 v44, v44, v14
    v_sub_f32 v45, v45, v14
    v_sub_f32 v46, v46, v14
    v_sub_f32 v47, v47, v14
    v_mul_f32 v40, s62, v40
    v_mul_f32 v41, s62, v41
    v_mul_f32 v42, s62, v42
    v_mul_f32 v43, s62, v43
    v_mul_f32 v44, s62, v44
    v_mul_f32 v45, s62, v45
    v_mul_f32 v46, s62, v46
    v_mul_f32 v47, s62, v47
    v_exp_f32 v40, v40
    v_exp_f32 v41, v41
    v_exp_f32 v42, v42
    v_exp_f32 v43, v43
    v_exp_f32 v44, v44
    v_exp_f32 v45, v45
    v_exp_f32 v46, v46
    v_exp_f32 v47, v47
    v_mul_f32 v40, v40, v13
    v_mul_f32 v41, v41, v13
    v_mul_f32 v42, v42, v13
    v_mul_f32 v43, v43, v13
    v_mul_f32 v44, v44, v13
    v_mul_f32 v45, v45, v13
    v_mul_f32 v46, v46, v13
    v_mul_f32 v47, v47, v13
    v_cvt_pk_bf16_f32 v36, v40, v41
    v_cvt_pk_bf16_f32 v37, v42, v43
    v_cvt_pk_bf16_f32 v38, v44, v45
    v_cvt_pk_bf16_f32 v39, v46, v47
    ds_write_b128 v21, v[36:39] offset:13376
    s_waitcnt lgkmcnt(0)
    s_mov_b64 exec, 1
    ds_add_u32 v7, v3 offset:32
    s_mov_b64 exec, -1
    s_lshl_b32 s65, s63, 12
    s_lshl_b32 s9, s11, 10
    s_add_u32 s65, s65, s9
    s_add_u32 s65, s65, 1048576
    s_mov_b32 s56, 0xffff0000
    s_mov_b32 s57, 0xffff0000
    s_mov_b32 s58, 0
    s_mov_b32 s59, -1
    s_mov_b32 s40, s34
    s_mov_b32 s41, s35
    s_mov_b32 s42, 3584
    s_mov_b32 s43, 0x20000
    s_and_b32 s8, s2, 7
    s_lshl_b32 s8, s8, 5
    s_lshr_b32 s9, s2, 3
    s_add_u32 s8, s8, s9
    s_mul_i32 s70, s8, 1171
    s_lshr_b32 s70, s70, 16
    s_mul_i32 s9, s70, 56
    s_sub_u32 s71, s8, s9
    s_lshr_b32 s72, s70, 2
    s_xor_b32 s8, s11, 3
    s_or_b32 s72, s72, s8
    s_mov_b32 s73, 0
    s_cmp_lg_u32 s72, 0
    s_cbranch_scc1 L_nopre
    v_lshrrev_b32 v9, 2, v1
    v_and_b32 v10, 3, v1
    v_lshlrev_b32 v21, 12, v9
    v_lshl_add_u32 v21, v10, 4, v21
    v_lshrrev_b32 v9, 5, v1
    v_lshl_add_u32 v10, v10, 1, v9
    s_mul_i32 s8, s70, 448
    s_lshl_b32 s9, s71, 3
    s_add_u32 s8, s8, s9
    v_add_u32 v10, s8, v10
    v_lshlrev_b32 v7, 1, v10
    s_mov_b32 s44, s16
    s_mov_b32 s45, s17
    s_mov_b32 s46, 3584
    s_mov_b32 s47, 0x20000
    buffer_load_ushort v8, v7, s[44:47], 0 offen
    s_lshl_b32 s22, s70, 14
    s_lshl_b32 s8, s71, 6
    s_add_u32 s22, s22, s8
    s_add_u32 s22, s22, 262144
    s_lshl_b32 s24, s70, 18
    s_add_u32 s24, s24, s8
    s_add_u32 s24, s24, 1048576
    s_add_u32 s27, s24, 0
    s_add_u32 s26, s24, 4096
    s_add_u32 s25, s24, 8192
    s_add_u32 s24, s24, 12288
    v_lshrrev_b32 v9, 2, v1
    v_mul_u32_u24 v9, 12288, v9
    v_add_u32 v11, v21, v9
    v_mov_b32 v32, 0
    v_mov_b32 v33, 0
    v_mov_b32 v34, s52
    v_mov_b32 v35, s53
    s_mov_b32 s96, 0xffff
    s_mov_b32 s97, 0
    s_mov_b32 s9, 0
L_yf1:
    s_mov_b64 exec, s[96:97]
    buffer_load_dwordx4 v[32:35], v21, s[48:51], s22 offen sc1
    s_mov_b64 exec, -1
    s_waitcnt vmcnt(0)
    v_cmp_ne_u64 s[96:97], s[52:53], v[34:35]
    s_nop 0
    s_cmp_lg_u64 s[96:97], 0
    s_cbranch_scc0 L_yf2
    s_sleep 32
    s_add_u32 s9, s9, 1
    s_cmp_lt_u32 s9, 200000
    s_cbranch_scc1 L_yf1
L_yf2:
    s_waitcnt vmcnt(0)
    v_permlane32_swap_b32 v32, v33
    v_add_f32 v32, v32, v33
    v_mov_b32 v34, v32
    s_nop 1
    v_permlane16_swap_b32 v34, v32
    v_add_f32 v32, v32, v34
    s_nop 1
    v_add_f32_dpp v32, v32, v32 row_ror:8 row_mask:0xf bank_mask:0xf
    s_nop 1
    v_add_f32_dpp v32, v32, v32 row_ror:4 row_mask:0xf bank_mask:0xf
    v_cvt_pk_bf16_f32 v32, v32, v32
    v_lshlrev_b32 v32, 16, v32
    v_mov_b32 v22, v32
    v_lshlrev_b32 v8, 16, v8
    s_branch L_pre_done
L_nopre:
    s_xor_b32 s8, s63, 60
    s_or_b32 s8, s8, s11
    s_cmp_lg_u32 s8, 0
    s_cbranch_scc1 L_pre_done
    s_waitcnt lgkmcnt(0)
    v_lshlrev_b32 v10, 8, v1
    s_mov_b32 s20, 65536
    s_mov_b32 s21, 81920
    s_mov_b32 s22, 98304
    s_mov_b32 s23, 114688
    s_mov_b64 s[66:67], -1
    s_mov_b64 s[68:69], -1
    s_mov_b64 s[76:77], -1
    s_mov_b64 s[78:79], -1
    s_mov_b32 s9, 0
L_ep1:
    s_mov_b64 exec, s[66:67]
    buffer_load_dwordx4 v[32:35], v10, s[48:51], s20 offen sc1
    s_mov_b64 exec, s[68:69]
    buffer_load_dwordx4 v[36:39], v10, s[48:51], s21 offen sc1
    s_mov_b64 exec, s[76:77]
    buffer_load_dwordx4 v[40:43], v10, s[48:51], s22 offen sc1
    s_mov_b64 exec, s[78:79]
    buffer_load_dwordx4 v[44:47], v10, s[48:51], s23 offen sc1
    s_mov_b64 exec, -1
    s_waitcnt vmcnt(3)
    v_mov_b32 v48, v34
    v_or_b32 v49, 15, v35
    v_cmp_ne_u64 s[66:67], s[52:53], v[48:49]
    s_waitcnt vmcnt(2)
    v_mov_b32 v48, v38
    v_or_b32 v49, 15, v39
    v_cmp_ne_u64 s[68:69], s[52:53], v[48:49]
    s_waitcnt vmcnt(1)
    v_mov_b32 v48, v42
    v_or_b32 v49, 15, v43
    v_cmp_ne_u64 s[76:77], s[52:53], v[48:49]
    s_waitcnt vmcnt(0)
    v_mov_b32 v48, v46
    v_or_b32 v49, 15, v47
    v_cmp_ne_u64 s[78:79], s[52:53], v[48:49]
    s_nop 0
    s_or_b64 vcc, s[66:67], s[68:69]
    s_or_b64 vcc, vcc, s[76:77]
    s_or_b64 vcc, vcc, s[78:79]
    s_cbranch_scc0 L_ep2
    s_sleep 16
    s_add_u32 s9, s9, 1
    s_cmp_lt_u32 s9, 400000
    s_cbranch_scc1 L_ep1
L_ep2:
    s_mov_b64 exec, 1
    buffer_store_dwordx2 v[18:19], off, s[48:51], 0 offset:0 sc1
    s_mov_b64 exec, -1
L_pre_done:
    v_mov_b32 v18, s52
    v_mov_b32 v19, s53
    s_mov_b64 s[66:67], -1
    s_mov_b64 s[68:69], -1
    s_mov_b64 s[76:77], -1
    s_mov_b64 s[78:79], -1
    v_lshrrev_b32 v9, 2, v6
    v_lshlrev_b32 v4, 8, v9
    v_lshl_add_u32 v4, v5, 6, v4
    v_and_b32 v9, 3, v6
    v_lshl_add_u32 v4, v9, 4, v4
    s_barrier
    ds_read_b128 v[12:15], v4 offset:1024
    ds_read_b32 v10, v2 offset:48
    s_waitcnt lgkmcnt(1)
    v_add_f32 v12, v12, v13
    v_add_f32 v14, v14, v15
    v_add_f32 v12, v12, v14
    s_nop 1
    v_mov_b32_dpp v13, v12 quad_perm:[1,0,3,2] row_mask:0xf bank_mask:0xf
    v_cvt_pk_bf16_f32 v12, v12, v13
    s_nop 1
    v_mov_b32_dpp v24, v12 row_newbcast:0 row_mask:0xf bank_mask:0xf
    v_mov_b32_dpp v25, v12 row_newbcast:2 row_mask:0xf bank_mask:0xf
    v_mov_b32_dpp v26, v12 row_newbcast:4 row_mask:0xf bank_mask:0xf
    v_mov_b32_dpp v27, v12 row_newbcast:6 row_mask:0xf bank_mask:0xf
    v_mov_b32_dpp v28, v12 row_newbcast:8 row_mask:0xf bank_mask:0xf
    v_mov_b32_dpp v29, v12 row_newbcast:10 row_mask:0xf bank_mask:0xf
    v_mov_b32_dpp v30, v12 row_newbcast:12 row_mask:0xf bank_mask:0xf
    v_mov_b32_dpp v31, v12 row_newbcast:14 row_mask:0xf bank_mask:0xf
    v_mfma_f32_16x16x32_bf16 v[32:35], v[24:27], v[128:131], 0
    v_mfma_f32_16x16x32_bf16 v[36:39], v[24:27], v[136:139], 0
    v_mfma_f32_16x16x32_bf16 v[40:43], v[24:27], v[144:147], 0
    v_mfma_f32_16x16x32_bf16 v[44:47], v[24:27], v[152:155], 0
    v_mfma_f32_16x16x32_bf16 v[48:51], v[24:27], v[160:163], 0
    v_mfma_f32_16x16x32_bf16 v[52:55], v[24:27], v[168:171], 0
    v_mfma_f32_16x16x32_bf16 v[56:59], v[24:27], v[176:179], 0
    v_mfma_f32_16x16x32_bf16 v[60:63], v[24:27], v[184:187], 0
    v_mfma_f32_16x16x32_bf16 v[32:35], v[28:31], v[132:135], v[32:35]
    v_mfma_f32_16x16x32_bf16 v[36:39], v[28:31], v[140:143], v[36:39]
    v_mfma_f32_16x16x32_bf16 v[40:43], v[28:31], v[148:151], v[40:43]
    v_mfma_f32_16x16x32_bf16 v[44:47], v[28:31], v[156:159], v[44:47]
    v_mfma_f32_16x16x32_bf16 v[48:51], v[28:31], v[164:167], v[48:51]
    v_mfma_f32_16x16x32_bf16 v[52:55], v[28:31], v[172:175], v[52:55]
    v_mfma_f32_16x16x32_bf16 v[56:59], v[28:31], v[180:183], v[56:59]
    v_mfma_f32_16x16x32_bf16 v[60:63], v[28:31], v[188:191], v[60:63]
    s_nop 2
    v_cndmask_b32 v12, v32, v40, s[56:57]
    s_nop 2
    v_cndmask_b32 v14, v48, v56, s[56:57]
    v_cndmask_b32 v13, v36, v44, s[56:57]
    v_cndmask_b32 v15, v52, v60, s[56:57]
    v_cndmask_b32 v16, v12, v14, s[58:59]
    v_cndmask_b32 v17, v13, v15, s[58:59]
    s_mov_b64 exec, s[74:75]
    buffer_store_dwordx4 v[16:19], v20, s[48:51], s65 offen sc1
    s_cmp_lg_u32 s72, 0
    s_cbranch_scc1 L_hend
    s_memrealtime s[20:21]
    s_waitcnt lgkmcnt(0)
    v_readfirstlane_b32 s8, v10
    s_nop 0
    s_lshl_b32 s20, s20, 4
    s_sub_u32 s8, s8, s20
    s_add_u32 s8, s8, 3200
    s_min_i32 s8, s8, 2880
    s_max_i32 s8, s8, 640
L_yb1:
    s_cmp_le_i32 s8, 0
    s_cbranch_scc1 L_yb2
    s_sleep 2
    s_sub_i32 s8, s8, 100
    s_branch L_yb1
L_yb2:
    s_mov_b32 s9, 0
L_y1:
    s_mov_b64 exec, s[66:67]
    buffer_load_dwordx4 v[32:35], v11, s[48:51], s24 offen sc1
    s_mov_b64 exec, s[68:69]
    buffer_load_dwordx4 v[36:39], v11, s[48:51], s25 offen sc1
    s_mov_b64 exec, s[76:77]
    buffer_load_dwordx4 v[40:43], v11, s[48:51], s26 offen sc1
    s_mov_b64 exec, s[78:79]
    buffer_load_dwordx4 v[44:47], v11, s[48:51], s27 offen sc1
    s_mov_b64 exec, -1
    s_waitcnt vmcnt(3)
    v_cmp_ne_u64 s[66:67], s[52:53], v[34:35]
    s_waitcnt vmcnt(2)
    v_cmp_ne_u64 s[68:69], s[52:53], v[38:39]
    s_waitcnt vmcnt(1)
    v_cmp_ne_u64 s[76:77], s[52:53], v[42:43]
    s_waitcnt vmcnt(0)
    v_cmp_ne_u64 s[78:79], s[52:53], v[46:47]
    s_nop 0
    s_or_b64 vcc, s[66:67], s[68:69]
    s_or_b64 vcc, vcc, s[76:77]
    s_or_b64 vcc, vcc, s[78:79]
    s_cbranch_scc0 L_y2
    s_add_u32 s9, s9, 1
    s_cmp_lt_u32 s9, 400000
    s_cbranch_scc1 L_y1
L_y2:
    v_add_f32 v32, v32, v36
    v_add_f32 v33, v33, v37
    v_add_f32 v40, v40, v44
    v_add_f32 v41, v41, v45
    v_add_f32 v32, v32, v40
    v_add_f32 v33, v33, v41
    s_nop 1
    v_permlane32_swap_b32 v32, v33
    v_add_f32 v32, v32, v33
    v_mov_b32 v34, v32
    s_nop 1
    v_permlane16_swap_b32 v34, v32
    v_add_f32 v32, v32, v34
    s_nop 1
    v_add_f32_dpp v32, v32, v32 row_ror:8 row_mask:0xf bank_mask:0xf
    s_nop 1
    v_add_f32_dpp v32, v32, v32 row_ror:4 row_mask:0xf bank_mask:0xf
    v_cvt_pk_bf16_f32 v32, v32, v32
    v_lshlrev_b32 v32, 16, v32
    v_add_f32 v32, v8, v32
    v_cvt_pk_bf16_f32 v32, v32, v32
    v_lshlrev_b32 v32, 16, v32
    v_add_f32 v32, v32, v22
    v_cvt_pk_bf16_f32 v32, v32, v32
    s_mov_b32 exec_lo, 15
    s_mov_b32 exec_hi, 15
    buffer_store_short v32, v7, s[40:43], 0 offen
L_hend:
L_end:
    s_endpgm
.section .rodata,"a"
.p2align 6
.amdhsa_kernel parallel_sum__mha_block_cached__geglu_ffn__decode_kernel
  .amdhsa_next_free_vgpr 256
  .amdhsa_next_free_sgpr 102
  .amdhsa_accum_offset 256
  .amdhsa_group_segment_fixed_size 0
  .amdhsa_kernarg_size 96
  .amdhsa_user_sgpr_count 2
  .amdhsa_user_sgpr_kernarg_segment_ptr 1
  .amdhsa_system_sgpr_workgroup_id_x 1
  .amdhsa_float_denorm_mode_32 3
.end_amdhsa_kernel
```
